```python
import torch

def _softmax(x, axis=-1):
    return torch.softmax(x, dim=axis)
def _gelu(x):
    return torch.nn.functional.gelu(x, approximate="tanh")
def _silu(x):
    return torch.nn.functional.silu(x)
def _sigmoid(x):
    return torch.sigmoid(x)
def _layernorm(x, axis=-1, eps=1e-5):
    m = x.mean(dim=axis, keepdim=True)
    v = x.var(dim=axis, keepdim=True, unbiased=False)
    return (x - m) / torch.sqrt(v + eps)
def _scatter_add(tgt, idx, src, axis=0):
    return tgt.clone().index_add_(axis, idx, src)
def _segment_sum(src, seg, n):
    out = torch.zeros((n,) + src.shape[1:], dtype=src.dtype)
    return out.index_add_(0, seg, src)
def _pad(x, pw):
    flat = tuple(v for pair in reversed(pw) for v in pair)
    return torch.nn.functional.pad(x, flat)

kernel_name = 'standalone__mha_block_cached__decode'

def setup_inputs():

    _w = (lambda a: (lambda t: t.to(torch.bfloat16) if t.is_floating_point() else t)(torch.as_tensor(a)))
    B, Sq, D = 2, 1, 448
    H, Sk, Dh = 16, 8192, 256
    return {
        "x": _w((lambda *s: torch.randn(*s, dtype=torch.bfloat16) * 0.8)(B, Sq, D)),
        "k_cache": _w((lambda *s: torch.randn(*s, dtype=torch.bfloat16) * 0.8)(B, H, Sk, Dh)),
        "v_cache": _w((lambda *s: torch.randn(*s, dtype=torch.bfloat16) * 0.05)(B, H, Sk, Dh)),
        "wq": _w((lambda *s: torch.randn(*s, dtype=torch.bfloat16) * 0.8)(D, H * Dh) * (D ** -0.5)),
        "wo": _w((lambda *s: torch.randn(*s, dtype=torch.bfloat16) * 0.05)(H * Dh, D) * ((H * Dh) ** -0.5)),
    }

def reference(x, k_cache, v_cache, wq, wo):
    B, Sq, D = x.shape
    H, Dh = 16, 256
    q = (lambda x, *d: x.permute(*d))((x @ wq).reshape(B, Sq, H, Dh), 0, 2, 1, 3)
    scores = torch.einsum("bhqd,bhkd->bhqk", q, k_cache) * (Dh ** -0.5)
    p = _softmax(scores, axis=-1)
    o = torch.einsum("bhqk,bhkd->bhqd", p, v_cache)
    return (lambda x, *d: x.permute(*d))(o, 0, 2, 1, 3).reshape(B, Sq, H * Dh) @ wo
```

```asm
; @launch grid=(256,1,1) block=(512,1,1) lds=9728
.amdgcn_target "amdgcn-amd-amdhsa--gfx950"
.text
.globl standalone__mha_block_cached__decode_kernel
.p2align 8
.type standalone__mha_block_cached__decode_kernel,@function
standalone__mha_block_cached__decode_kernel:
  s_load_dwordx16 s[4:19], s[0:1], 0
  s_cmp_ge_u32 s2, 256
  s_cbranch_scc1 L_end
  v_lshrrev_b32 v1, 6, v0
  v_and_b32 v0, 63, v0
  v_readfirstlane_b32 s3, v1
  s_lshr_b32 s60, s2, 3
  s_and_b32 s33, s60, 7
  s_and_b32 s60, s60, 24
  s_and_b32 s32, s2, 7
  s_or_b32 s32, s32, s60
  s_cmp_lg_u32 s3, 7
  s_cbranch_scc1 L_nopf
  s_getpc_b64 s[92:93]
  s_lshr_b32 s94, s2, 3
  s_lshl_b32 s94, s94, 9
  s_min_u32 s94, s94, (L_end - standalone__mha_block_cached__decode_kernel - 640)
  v_lshl_add_u32 v2, v0, 3, s94
  v_mov_b32 v3, s93
  v_add_co_u32 v2, vcc, s92, v2
  s_nop 1
  v_addc_co_u32 v3, vcc, 0, v3, vcc
  global_load_dword v127, v[2:3], off
L_nopf:
  s_mov_b32 s23, 0x20000
  s_mov_b32 s27, 0x20000
  s_mov_b32 s31, 0x20000
  s_mov_b32 s26, 4194304
  s_cmp_ge_u32 s3, 4
  s_cbranch_scc1 L_helper
  v_mov_b32 v52, v0
  v_lshlrev_b32 v0, 4, v0
  s_lshl_b32 s87, s32, 1
  s_lshr_b32 s60, s33, 2
  s_add_u32 s87, s87, s60
  s_lshl_b32 s87, s87, 21
  s_and_b32 s60, s33, 3
  s_lshl_b32 s60, s60, 2
  s_add_u32 s60, s60, s3
  s_lshl_b32 s39, s60, 12
  s_mul_i32 s60, s32, 65536
  s_add_u32 s39, s39, s60
  s_and_b32 s39, s39, 2097151
  s_add_u32 s37, s39, s87
  s_mov_b32 s22, 0x8000000
  s_waitcnt lgkmcnt(0)
  s_mov_b32 s20, s6
  s_mov_b32 s21, s7
  buffer_load_dwordx4 v[64:67], v0, s[20:23], s37 offen offset:0 nt
  buffer_load_dwordx4 v[68:71], v0, s[20:23], s37 offen offset:1024 nt
  buffer_load_dwordx4 v[72:75], v0, s[20:23], s37 offen offset:2048 nt
  buffer_load_dwordx4 v[76:79], v0, s[20:23], s37 offen offset:3072 nt
  s_add_u32 s39, s39, 65536
  s_and_b32 s39, s39, 2097151
  s_add_u32 s37, s39, s87
  buffer_load_dwordx4 v[80:83], v0, s[20:23], s37 offen offset:0 nt
  s_barrier
  s_mov_b32 s24, s18
  s_mov_b32 s25, s19
  s_mov_b32 s48, 0xcccccccc
  s_mov_b32 s49, 0xcccccccc
  s_mov_b32 s50, 0xaaaaaaaa
  s_mov_b32 s51, 0xaaaaaaaa
  s_mov_b32 s69, 0x3db8aa3b
  v_lshrrev_b32 v44, 3, v52
  v_lshrrev_b32 v45, 4, v52
  v_xor_b32 v44, v44, v45
  v_and_b32 v44, 1, v44
  v_lshlrev_b32 v44, 2, v44
  v_bfe_u32 v45, v52, 1, 2
  v_or_b32 v44, v44, v45
  v_and_b32 v45, 1, v52
  v_lshlrev_b32 v45, 4, v45
  v_mov_b32 v46, 0xffff
  v_lshlrev_b32 v46, v45, v46
  v_cmp_eq_u32 vcc, 0, v44
  v_mov_b32 v16, 0
  s_nop 0
  v_cndmask_b32 v8, 0, v46, vcc
  v_cmp_eq_u32 vcc, 1, v44
  v_mov_b32 v17, 0
  s_nop 0
  v_cndmask_b32 v9, 0, v46, vcc
  v_cmp_eq_u32 vcc, 2, v44
  v_mov_b32 v18, 0
  s_nop 0
  v_cndmask_b32 v10, 0, v46, vcc
  v_cmp_eq_u32 vcc, 3, v44
  v_mov_b32 v19, 0
  s_nop 0
  v_cndmask_b32 v11, 0, v46, vcc
  v_and_b32 v47, 31, v52
  v_lshlrev_b32 v47, 4, v47
  v_mov_b32 v54, 0
  s_mov_b32 s90, 0x88ff
  s_lshl_b32 s60, s3, 8
  v_lshl_add_u32 v55, v52, 2, s60
  s_lshl_b32 s60, s3, 2
  v_mov_b32 v56, s60
  v_mov_b32 v53, s90
  s_waitcnt vmcnt(4)
  buffer_load_dwordx4 v[84:87], v0, s[20:23], s37 offen offset:1024 nt
  s_waitcnt vmcnt(4)
  buffer_load_dwordx4 v[88:91], v0, s[20:23], s37 offen offset:2048 nt
  s_waitcnt vmcnt(4)
  buffer_load_dwordx4 v[92:95], v0, s[20:23], s37 offen offset:3072 nt
  s_add_u32 s39, s39, 65536
  s_and_b32 s39, s39, 2097151
  s_add_u32 s37, s39, s87
  s_waitcnt vmcnt(4)
  buffer_load_dwordx4 v[96:99], v0, s[20:23], s37 offen offset:0 nt
  s_waitcnt vmcnt(4)
  buffer_load_dwordx4 v[100:103], v0, s[20:23], s37 offen offset:1024 nt
  s_mov_b32 s44, 0x07060500
  s_mov_b32 s45, 0x07060501
  s_mov_b32 s46, 0x07060502
  s_mov_b32 s47, 0x07060503
  s_lshl_b32 s60, s3, 10
  v_add_u32 v61, s60, v0
  v_lshlrev_b32 v60, 2, v52
  v_mov_b32 v62, 1
  s_lshl_b32 s65, s32, 3
  s_add_u32 s65, s65, s33
  s_lshl_b32 s65, s65, 10
  s_add_u32 s65, s65, 524288
  s_lshr_b32 s93, s2, 4
  s_lshl_b32 s91, s93, 14
  s_bfe_u32 s38, s2, 0x10003
  s_lshl_b32 s38, s38, 7
  s_add_u32 s91, s91, s38
  s_lshl_b32 s38, s3, 11
  s_add_u32 s91, s91, s38
  s_add_u32 s91, s91, 1048576
  s_and_b32 s38, s2, 7
  s_cmp_eq_u32 s38, 0
  s_cselect_b32 s93, s93, 99
  v_lshrrev_b32 v57, 3, v52
  v_lshlrev_b32 v57, 8, v57
  v_and_b32 v59, 7, v52
  v_lshl_add_u32 v57, v59, 4, v57
  s_lshr_b32 s92, s2, 3
  s_lshl_b32 s92, s92, 6
  s_mov_b32 s28, s14
  s_mov_b32 s29, s15
  s_mov_b32 s30, 1792
  v_lshrrev_b32 v58, 5, v52
  v_lshl_add_u32 v58, v59, 2, v58
  v_bfe_u32 v59, v52, 4, 1
  v_lshl_add_u32 v58, v59, 1, v58
  v_lshlrev_b32 v58, 1, v58
  s_waitcnt vmcnt(4)
  buffer_load_dwordx4 v[104:107], v0, s[20:23], s37 offen offset:2048 nt
  s_waitcnt vmcnt(4)
  buffer_load_dwordx4 v[108:111], v0, s[20:23], s37 offen offset:3072 nt
  s_add_u32 s39, s39, 65536
  s_and_b32 s39, s39, 2097151
  s_add_u32 s37, s39, s87
  s_waitcnt vmcnt(4)
  buffer_load_dwordx4 v[112:115], v0, s[20:23], s37 offen offset:0 nt
  s_waitcnt vmcnt(4)
  buffer_load_dwordx4 v[116:119], v0, s[20:23], s37 offen offset:1024 nt
  s_waitcnt vmcnt(4)
  buffer_load_dwordx4 v[120:123], v0, s[20:23], s37 offen offset:2048 nt
  s_waitcnt vmcnt(4)
  buffer_load_dwordx4 v[124:127], v0, s[20:23], s37 offen offset:3072 nt
  s_add_u32 s39, s39, 65536
  s_and_b32 s39, s39, 2097151
  s_add_u32 s37, s39, s87
  s_waitcnt vmcnt(4)
  buffer_load_dwordx4 v[128:131], v0, s[20:23], s37 offen offset:0 nt
  s_waitcnt vmcnt(4)
  buffer_load_dwordx4 v[132:135], v0, s[20:23], s37 offen offset:1024 nt
  s_waitcnt vmcnt(4)
  buffer_load_dwordx4 v[136:139], v0, s[20:23], s37 offen offset:2048 nt
  s_waitcnt vmcnt(4)
  buffer_load_dwordx4 v[140:143], v0, s[20:23], s37 offen offset:3072 nt
  s_add_u32 s39, s39, 65536
  s_and_b32 s39, s39, 2097151
  s_add_u32 s37, s39, s87
  s_waitcnt vmcnt(4)
  buffer_load_dwordx4 v[144:147], v0, s[20:23], s37 offen offset:0 nt
  s_waitcnt vmcnt(4)
  buffer_load_dwordx4 v[148:151], v0, s[20:23], s37 offen offset:1024 nt
  s_waitcnt vmcnt(4)
  buffer_load_dwordx4 v[152:155], v0, s[20:23], s37 offen offset:2048 nt
  s_waitcnt vmcnt(4)
  buffer_load_dwordx4 v[156:159], v0, s[20:23], s37 offen offset:3072 nt
  s_add_u32 s39, s39, 65536
  s_and_b32 s39, s39, 2097151
  s_add_u32 s37, s39, s87
  s_waitcnt vmcnt(4)
  buffer_load_dwordx4 v[160:163], v0, s[20:23], s37 offen offset:0 nt
  s_waitcnt vmcnt(4)
  buffer_load_dwordx4 v[164:167], v0, s[20:23], s37 offen offset:1024 nt
  s_waitcnt vmcnt(4)
  buffer_load_dwordx4 v[168:171], v0, s[20:23], s37 offen offset:2048 nt
  s_waitcnt vmcnt(4)
  buffer_load_dwordx4 v[172:175], v0, s[20:23], s37 offen offset:3072 nt
  s_add_u32 s39, s39, 65536
  s_and_b32 s39, s39, 2097151
  s_add_u32 s37, s39, s87
  s_waitcnt vmcnt(4)
  buffer_load_dwordx4 v[176:179], v0, s[20:23], s37 offen offset:0 nt
  s_waitcnt vmcnt(4)
  buffer_load_dwordx4 v[180:183], v0, s[20:23], s37 offen offset:1024 nt
  s_waitcnt vmcnt(4)
  buffer_load_dwordx4 v[184:187], v0, s[20:23], s37 offen offset:2048 nt
  s_waitcnt vmcnt(4)
  buffer_load_dwordx4 v[188:191], v0, s[20:23], s37 offen offset:3072 nt
  s_add_u32 s39, s39, 65536
  s_and_b32 s39, s39, 2097151
  s_add_u32 s37, s39, s87
  s_mov_b32 s68, 16777216
L_qwait:
  ds_read_b32 v49, v54 offset:516
  ds_read_b128 v[4:7], v47 offset:0
  s_sub_u32 s68, s68, 1
  s_cmp_eq_u32 s68, 0
  s_waitcnt lgkmcnt(0)
  s_cbranch_scc1 L_qok
  v_cmp_eq_u32 vcc, 0, v49
  s_cbranch_vccnz L_qwait
L_qok:
  v_dot2_f32_bf16 v20, v64, v4, 0
  v_dot2_f32_bf16 v20, v65, v5, v20
  v_dot2_f32_bf16 v20, v66, v6, v20
  v_dot2_f32_bf16 v20, v67, v7, v20
  v_dot2_f32_bf16 v21, v68, v4, 0
  v_dot2_f32_bf16 v21, v69, v5, v21
  v_dot2_f32_bf16 v21, v70, v6, v21
  v_dot2_f32_bf16 v21, v71, v7, v21
  s_waitcnt vmcnt(4)
  buffer_load_dwordx4 v[64:67], v0, s[20:23], s37 offen offset:0 nt
  v_dot2_f32_bf16 v22, v72, v4, 0
  v_dot2_f32_bf16 v22, v73, v5, v22
  v_dot2_f32_bf16 v22, v74, v6, v22
  v_dot2_f32_bf16 v22, v75, v7, v22
  v_dot2_f32_bf16 v23, v76, v4, 0
  v_dot2_f32_bf16 v23, v77, v5, v23
  v_dot2_f32_bf16 v23, v78, v6, v23
  v_dot2_f32_bf16 v23, v79, v7, v23
  v_dot2_f32_bf16 v24, v80, v4, 0
  v_dot2_f32_bf16 v24, v81, v5, v24
  v_dot2_f32_bf16 v24, v82, v6, v24
  v_dot2_f32_bf16 v24, v83, v7, v24
  s_waitcnt vmcnt(4)
  buffer_load_dwordx4 v[68:71], v0, s[20:23], s37 offen offset:1024 nt
  v_dot2_f32_bf16 v25, v84, v4, 0
  v_dot2_f32_bf16 v25, v85, v5, v25
  v_dot2_f32_bf16 v25, v86, v6, v25
  v_dot2_f32_bf16 v25, v87, v7, v25
  v_dot2_f32_bf16 v26, v88, v4, 0
  v_dot2_f32_bf16 v26, v89, v5, v26
  v_dot2_f32_bf16 v26, v90, v6, v26
  v_dot2_f32_bf16 v26, v91, v7, v26
  v_dot2_f32_bf16 v27, v92, v4, 0
  v_dot2_f32_bf16 v27, v93, v5, v27
  v_dot2_f32_bf16 v27, v94, v6, v27
  v_dot2_f32_bf16 v27, v95, v7, v27
  s_waitcnt vmcnt(4)
  buffer_load_dwordx4 v[72:75], v0, s[20:23], s37 offen offset:2048 nt
  v_dot2_f32_bf16 v28, v96, v4, 0
  v_dot2_f32_bf16 v28, v97, v5, v28
  v_dot2_f32_bf16 v28, v98, v6, v28
  v_dot2_f32_bf16 v28, v99, v7, v28
  v_dot2_f32_bf16 v29, v100, v4, 0
  v_dot2_f32_bf16 v29, v101, v5, v29
  v_dot2_f32_bf16 v29, v102, v6, v29
  v_dot2_f32_bf16 v29, v103, v7, v29
  v_dot2_f32_bf16 v30, v104, v4, 0
  v_dot2_f32_bf16 v30, v105, v5, v30
  v_dot2_f32_bf16 v30, v106, v6, v30
  v_dot2_f32_bf16 v30, v107, v7, v30
  v_dot2_f32_bf16 v31, v108, v4, 0
  v_dot2_f32_bf16 v31, v109, v5, v31
  v_dot2_f32_bf16 v31, v110, v6, v31
  v_dot2_f32_bf16 v31, v111, v7, v31
  s_waitcnt vmcnt(4)
  buffer_load_dwordx4 v[76:79], v0, s[20:23], s37 offen offset:3072 nt
  s_add_u32 s39, s39, 65536
  s_and_b32 s39, s39, 2097151
  s_add_u32 s37, s39, s87
  v_dot2_f32_bf16 v32, v112, v4, 0
  v_dot2_f32_bf16 v32, v113, v5, v32
  v_dot2_f32_bf16 v32, v114, v6, v32
  v_dot2_f32_bf16 v32, v115, v7, v32
  v_dot2_f32_bf16 v33, v116, v4, 0
  v_dot2_f32_bf16 v33, v117, v5, v33
  v_dot2_f32_bf16 v33, v118, v6, v33
  v_dot2_f32_bf16 v33, v119, v7, v33
  v_dot2_f32_bf16 v34, v120, v4, 0
  v_dot2_f32_bf16 v34, v121, v5, v34
  v_dot2_f32_bf16 v34, v122, v6, v34
  v_dot2_f32_bf16 v34, v123, v7, v34
  s_waitcnt vmcnt(4)
  buffer_load_dwordx4 v[80:83], v0, s[20:23], s37 offen offset:0 nt
  v_dot2_f32_bf16 v35, v124, v4, 0
  v_dot2_f32_bf16 v35, v125, v5, v35
  v_dot2_f32_bf16 v35, v126, v6, v35
  v_dot2_f32_bf16 v35, v127, v7, v35
  v_mov_b32 v36, v37
  v_mov_b32 v37, v38
  v_mov_b32 v38, v39
  v_mov_b32 v39, v40
  v_mov_b32 v40, v41
  v_mov_b32 v41, v42
  v_mov_b32 v42, v43
  v_add_f32_dpp v20, v20, v20 row_ror:8 row_mask:0xf bank_mask:0x3
  v_add_f32_dpp v21, v21, v21 row_ror:8 row_mask:0xf bank_mask:0x3
  v_add_f32_dpp v22, v22, v22 row_ror:8 row_mask:0xf bank_mask:0x3
  v_add_f32_dpp v23, v23, v23 row_ror:8 row_mask:0xf bank_mask:0x3
  v_add_f32_dpp v24, v24, v24 row_ror:8 row_mask:0xf bank_mask:0x3
  v_add_f32_dpp v25, v25, v25 row_ror:8 row_mask:0xf bank_mask:0x3
  v_add_f32_dpp v26, v26, v26 row_ror:8 row_mask:0xf bank_mask:0x3
  v_add_f32_dpp v27, v27, v27 row_ror:8 row_mask:0xf bank_mask:0x3
  v_add_f32_dpp v20, v28, v28 row_ror:8 row_mask:0xf bank_mask:0xc
  v_add_f32_dpp v21, v29, v29 row_ror:8 row_mask:0xf bank_mask:0xc
  v_add_f32_dpp v22, v30, v30 row_ror:8 row_mask:0xf bank_mask:0xc
  v_add_f32_dpp v23, v31, v31 row_ror:8 row_mask:0xf bank_mask:0xc
  v_add_f32_dpp v24, v32, v32 row_ror:8 row_mask:0xf bank_mask:0xc
  v_add_f32_dpp v25, v33, v33 row_ror:8 row_mask:0xf bank_mask:0xc
  v_add_f32_dpp v26, v34, v34 row_ror:8 row_mask:0xf bank_mask:0xc
  v_add_f32_dpp v27, v35, v35 row_ror:8 row_mask:0xf bank_mask:0xc
  v_add_f32_dpp v20, v20, v20 row_half_mirror row_mask:0xf bank_mask:0x5
  v_add_f32_dpp v21, v21, v21 row_half_mirror row_mask:0xf bank_mask:0x5
  v_add_f32_dpp v22, v22, v22 row_half_mirror row_mask:0xf bank_mask:0x5
  v_add_f32_dpp v23, v23, v23 row_half_mirror row_mask:0xf bank_mask:0x5
  v_add_f32_dpp v20, v24, v24 row_half_mirror row_mask:0xf bank_mask:0xa
  v_add_f32_dpp v21, v25, v25 row_half_mirror row_mask:0xf bank_mask:0xa
  v_add_f32_dpp v22, v26, v26 row_half_mirror row_mask:0xf bank_mask:0xa
  v_add_f32_dpp v23, v27, v27 row_half_mirror row_mask:0xf bank_mask:0xa
  v_cndmask_b32 v29, v22, v20, s[48:49]
  v_cndmask_b32 v31, v23, v21, s[48:49]
  v_cndmask_b32 v28, v20, v22, s[48:49]
  v_cndmask_b32 v30, v21, v23, s[48:49]
  s_nop 0
  v_add_f32_dpp v20, v29, v28 quad_perm:[2,3,0,1] row_mask:0xf bank_mask:0xf
  v_add_f32_dpp v21, v31, v30 quad_perm:[2,3,0,1] row_mask:0xf bank_mask:0xf
  v_cndmask_b32 v29, v21, v20, s[50:51]
  v_cndmask_b32 v28, v20, v21, s[50:51]
  s_nop 1
  v_add_f32_dpp v20, v29, v28 quad_perm:[1,0,3,2] row_mask:0xf bank_mask:0xf
  v_mov_b32 v21, v20
  s_nop 1
  v_permlane16_swap_b32 v20, v21
  v_add_f32 v20, v20, v21
  v_cvt_pk_bf16_f32 v20, v20, v20
  v_and_b32 v43, 0xffff0000, v20
  v_dot2_f32_bf16 v20, v128, v4, 0
  v_dot2_f32_bf16 v20, v129, v5, v20
  v_dot2_f32_bf16 v20, v130, v6, v20
  v_dot2_f32_bf16 v20, v131, v7, v20
  v_dot2_f32_bf16 v21, v132, v4, 0
  v_dot2_f32_bf16 v21, v133, v5, v21
  v_dot2_f32_bf16 v21, v134, v6, v21
  v_dot2_f32_bf16 v21, v135, v7, v21
  v_dot2_f32_bf16 v22, v136, v4, 0
  v_dot2_f32_bf16 v22, v137, v5, v22
  v_dot2_f32_bf16 v22, v138, v6, v22
  v_dot2_f32_bf16 v22, v139, v7, v22
  s_waitcnt vmcnt(4)
  buffer_load_dwordx4 v[84:87], v0, s[20:23], s37 offen offset:1024 nt
  v_dot2_f32_bf16 v23, v140, v4, 0
  v_dot2_f32_bf16 v23, v141, v5, v23
  v_dot2_f32_bf16 v23, v142, v6, v23
  v_dot2_f32_bf16 v23, v143, v7, v23
  v_dot2_f32_bf16 v24, v144, v4, 0
  v_dot2_f32_bf16 v24, v145, v5, v24
  v_dot2_f32_bf16 v24, v146, v6, v24
  v_dot2_f32_bf16 v24, v147, v7, v24
  v_dot2_f32_bf16 v25, v148, v4, 0
  v_dot2_f32_bf16 v25, v149, v5, v25
  v_dot2_f32_bf16 v25, v150, v6, v25
  v_dot2_f32_bf16 v25, v151, v7, v25
  s_waitcnt vmcnt(4)
  buffer_load_dwordx4 v[88:91], v0, s[20:23], s37 offen offset:2048 nt
  v_dot2_f32_bf16 v26, v152, v4, 0
  v_dot2_f32_bf16 v26, v153, v5, v26
  v_dot2_f32_bf16 v26, v154, v6, v26
  v_dot2_f32_bf16 v26, v155, v7, v26
  v_dot2_f32_bf16 v27, v156, v4, 0
  v_dot2_f32_bf16 v27, v157, v5, v27
  v_dot2_f32_bf16 v27, v158, v6, v27
  v_dot2_f32_bf16 v27, v159, v7, v27
  v_dot2_f32_bf16 v28, v160, v4, 0
  v_dot2_f32_bf16 v28, v161, v5, v28
  v_dot2_f32_bf16 v28, v162, v6, v28
  v_dot2_f32_bf16 v28, v163, v7, v28
  s_waitcnt vmcnt(4)
  buffer_load_dwordx4 v[92:95], v0, s[20:23], s37 offen offset:3072 nt
  s_add_u32 s39, s39, 65536
  s_and_b32 s39, s39, 2097151
  s_add_u32 s37, s39, s87
  v_dot2_f32_bf16 v29, v164, v4, 0
  v_dot2_f32_bf16 v29, v165, v5, v29
  v_dot2_f32_bf16 v29, v166, v6, v29
  v_dot2_f32_bf16 v29, v167, v7, v29
  v_dot2_f32_bf16 v30, v168, v4, 0
  v_dot2_f32_bf16 v30, v169, v5, v30
  v_dot2_f32_bf16 v30, v170, v6, v30
  v_dot2_f32_bf16 v30, v171, v7, v30
  v_dot2_f32_bf16 v31, v172, v4, 0
  v_dot2_f32_bf16 v31, v173, v5, v31
  v_dot2_f32_bf16 v31, v174, v6, v31
  v_dot2_f32_bf16 v31, v175, v7, v31
  v_dot2_f32_bf16 v32, v176, v4, 0
  v_dot2_f32_bf16 v32, v177, v5, v32
  v_dot2_f32_bf16 v32, v178, v6, v32
  v_dot2_f32_bf16 v32, v179, v7, v32
  v_dot2_f32_bf16 v33, v180, v4, 0
  v_dot2_f32_bf16 v33, v181, v5, v33
  v_dot2_f32_bf16 v33, v182, v6, v33
  v_dot2_f32_bf16 v33, v183, v7, v33
  v_dot2_f32_bf16 v34, v184, v4, 0
  v_dot2_f32_bf16 v34, v185, v5, v34
  v_dot2_f32_bf16 v34, v186, v6, v34
  v_dot2_f32_bf16 v34, v187, v7, v34
  v_dot2_f32_bf16 v35, v188, v4, 0
  v_dot2_f32_bf16 v35, v189, v5, v35
  v_dot2_f32_bf16 v35, v190, v6, v35
  v_dot2_f32_bf16 v35, v191, v7, v35
  v_mov_b32 v36, v37
  v_mov_b32 v37, v38
  v_mov_b32 v38, v39
  v_mov_b32 v39, v40
  v_mov_b32 v40, v41
  v_mov_b32 v41, v42
  v_mov_b32 v42, v43
  v_add_f32_dpp v20, v20, v20 row_ror:8 row_mask:0xf bank_mask:0x3
  v_add_f32_dpp v21, v21, v21 row_ror:8 row_mask:0xf bank_mask:0x3
  v_add_f32_dpp v22, v22, v22 row_ror:8 row_mask:0xf bank_mask:0x3
  v_add_f32_dpp v23, v23, v23 row_ror:8 row_mask:0xf bank_mask:0x3
  v_add_f32_dpp v24, v24, v24 row_ror:8 row_mask:0xf bank_mask:0x3
  v_add_f32_dpp v25, v25, v25 row_ror:8 row_mask:0xf bank_mask:0x3
  v_add_f32_dpp v26, v26, v26 row_ror:8 row_mask:0xf bank_mask:0x3
  v_add_f32_dpp v27, v27, v27 row_ror:8 row_mask:0xf bank_mask:0x3
  v_add_f32_dpp v20, v28, v28 row_ror:8 row_mask:0xf bank_mask:0xc
  v_add_f32_dpp v21, v29, v29 row_ror:8 row_mask:0xf bank_mask:0xc
  v_add_f32_dpp v22, v30, v30 row_ror:8 row_mask:0xf bank_mask:0xc
  v_add_f32_dpp v23, v31, v31 row_ror:8 row_mask:0xf bank_mask:0xc
  v_add_f32_dpp v24, v32, v32 row_ror:8 row_mask:0xf bank_mask:0xc
  v_add_f32_dpp v25, v33, v33 row_ror:8 row_mask:0xf bank_mask:0xc
  v_add_f32_dpp v26, v34, v34 row_ror:8 row_mask:0xf bank_mask:0xc
  v_add_f32_dpp v27, v35, v35 row_ror:8 row_mask:0xf bank_mask:0xc
  v_add_f32_dpp v20, v20, v20 row_half_mirror row_mask:0xf bank_mask:0x5
  v_add_f32_dpp v21, v21, v21 row_half_mirror row_mask:0xf bank_mask:0x5
  v_add_f32_dpp v22, v22, v22 row_half_mirror row_mask:0xf bank_mask:0x5
  v_add_f32_dpp v23, v23, v23 row_half_mirror row_mask:0xf bank_mask:0x5
  v_add_f32_dpp v20, v24, v24 row_half_mirror row_mask:0xf bank_mask:0xa
  v_add_f32_dpp v21, v25, v25 row_half_mirror row_mask:0xf bank_mask:0xa
  v_add_f32_dpp v22, v26, v26 row_half_mirror row_mask:0xf bank_mask:0xa
  v_add_f32_dpp v23, v27, v27 row_half_mirror row_mask:0xf bank_mask:0xa
  v_cndmask_b32 v29, v22, v20, s[48:49]
  v_cndmask_b32 v31, v23, v21, s[48:49]
  v_cndmask_b32 v28, v20, v22, s[48:49]
  v_cndmask_b32 v30, v21, v23, s[48:49]
  s_nop 0
  v_add_f32_dpp v20, v29, v28 quad_perm:[2,3,0,1] row_mask:0xf bank_mask:0xf
  v_add_f32_dpp v21, v31, v30 quad_perm:[2,3,0,1] row_mask:0xf bank_mask:0xf
  v_cndmask_b32 v29, v21, v20, s[50:51]
  v_cndmask_b32 v28, v20, v21, s[50:51]
  s_nop 1
  v_add_f32_dpp v20, v29, v28 quad_perm:[1,0,3,2] row_mask:0xf bank_mask:0xf
  v_mov_b32 v21, v20
  s_nop 1
  v_permlane16_swap_b32 v20, v21
  v_add_f32 v20, v20, v21
  v_cvt_pk_bf16_f32 v20, v20, v20
  v_and_b32 v43, 0xffff0000, v20
  s_mov_b32 s38, 6
L_kloop:
  s_waitcnt lgkmcnt(0)
  v_readfirstlane_b32 s90, v53
  s_bitcmp1_b32 s90, 24
  s_cbranch_scc1 L_p1_3
  s_bitcmp1_b32 s90, 16
  s_cbranch_scc1 L_p1_2
  s_bitcmp1_b32 s90, 8
  s_cbranch_scc1 L_p1_1
  s_bitcmp1_b32 s90, 0
  s_cbranch_scc1 L_p1_0
  s_waitcnt vmcnt(3)
L_p1_0:
  s_waitcnt vmcnt(4)
L_p1_1:
  s_waitcnt vmcnt(5)
L_p1_2:
  s_waitcnt vmcnt(6)
L_p1_3:
  s_waitcnt vmcnt(7)
  buffer_load_dwordx4 v[96:99], v0, s[20:23], s37 offen offset:0 nt
  v_dot2_f32_bf16 v20, v64, v4, 0
  v_dot2_f32_bf16 v20, v65, v5, v20
  v_dot2_f32_bf16 v20, v66, v6, v20
  v_dot2_f32_bf16 v20, v67, v7, v20
  s_bitcmp1_b32 s90, 25
  s_cbranch_scc1 L_p2_3
  s_bitcmp1_b32 s90, 17
  s_cbranch_scc1 L_p2_2
  s_bitcmp1_b32 s90, 9
  s_cbranch_scc1 L_p2_1
  s_bitcmp1_b32 s90, 1
  s_cbranch_scc1 L_p2_0
  s_waitcnt vmcnt(3)
L_p2_0:
  s_waitcnt vmcnt(4)
L_p2_1:
  s_waitcnt vmcnt(5)
L_p2_2:
  s_waitcnt vmcnt(6)
L_p2_3:
  s_waitcnt vmcnt(7)
  buffer_load_dwordx4 v[100:103], v0, s[20:23], s37 offen offset:1024 nt
  v_add_u32 v54, 2, v54
  ds_write_b32 v55, v54 offset:1536
  ds_read_b32 v53, v56 offset:528
  v_dot2_f32_bf16 v21, v68, v4, 0
  v_dot2_f32_bf16 v21, v69, v5, v21
  v_dot2_f32_bf16 v21, v70, v6, v21
  v_dot2_f32_bf16 v21, v71, v7, v21
  s_waitcnt lgkmcnt(0)
  v_readfirstlane_b32 s90, v53
  s_bitcmp1_b32 s90, 26
  s_cbranch_scc1 L_p3_3
  s_bitcmp1_b32 s90, 18
  s_cbranch_scc1 L_p3_2
  s_bitcmp1_b32 s90, 10
  s_cbranch_scc1 L_p3_1
  s_bitcmp1_b32 s90, 2
  s_cbranch_scc1 L_p3_0
  s_waitcnt vmcnt(3)
L_p3_0:
  s_waitcnt vmcnt(4)
L_p3_1:
  s_waitcnt vmcnt(5)
L_p3_2:
  s_waitcnt vmcnt(6)
L_p3_3:
  s_waitcnt vmcnt(7)
  buffer_load_dwordx4 v[104:107], v0, s[20:23], s37 offen offset:2048 nt
  v_dot2_f32_bf16 v22, v72, v4, 0
  v_dot2_f32_bf16 v22, v73, v5, v22
  v_dot2_f32_bf16 v22, v74, v6, v22
  v_dot2_f32_bf16 v22, v75, v7, v22
  s_bitcmp1_b32 s90, 27
  s_cbranch_scc1 L_p4_3
  s_bitcmp1_b32 s90, 19
  s_cbranch_scc1 L_p4_2
  s_bitcmp1_b32 s90, 11
  s_cbranch_scc1 L_p4_1
  s_bitcmp1_b32 s90, 3
  s_cbranch_scc1 L_p4_0
  s_waitcnt vmcnt(3)
L_p4_0:
  s_waitcnt vmcnt(4)
L_p4_1:
  s_waitcnt vmcnt(5)
L_p4_2:
  s_waitcnt vmcnt(6)
L_p4_3:
  s_waitcnt vmcnt(7)
  buffer_load_dwordx4 v[108:111], v0, s[20:23], s37 offen offset:3072 nt
  s_add_u32 s39, s39, 65536
  s_and_b32 s39, s39, 2097151
  s_add_u32 s37, s39, s87
  v_add_u32 v54, 2, v54
  ds_write_b32 v55, v54 offset:1536
  ds_read_b32 v53, v56 offset:528
  v_dot2_f32_bf16 v23, v76, v4, 0
  v_dot2_f32_bf16 v23, v77, v5, v23
  v_dot2_f32_bf16 v23, v78, v6, v23
  v_dot2_f32_bf16 v23, v79, v7, v23
  s_waitcnt lgkmcnt(0)
  v_readfirstlane_b32 s90, v53
  s_bitcmp1_b32 s90, 28
  s_cbranch_scc1 L_p5_3
  s_bitcmp1_b32 s90, 20
  s_cbranch_scc1 L_p5_2
  s_bitcmp1_b32 s90, 12
  s_cbranch_scc1 L_p5_1
  s_bitcmp1_b32 s90, 4
  s_cbranch_scc1 L_p5_0
  s_waitcnt vmcnt(3)
L_p5_0:
  s_waitcnt vmcnt(4)
L_p5_1:
  s_waitcnt vmcnt(5)
L_p5_2:
  s_waitcnt vmcnt(6)
L_p5_3:
  s_waitcnt vmcnt(7)
  buffer_load_dwordx4 v[112:115], v0, s[20:23], s37 offen offset:0 nt
  v_dot2_f32_bf16 v24, v80, v4, 0
  v_dot2_f32_bf16 v24, v81, v5, v24
  v_dot2_f32_bf16 v24, v82, v6, v24
  v_dot2_f32_bf16 v24, v83, v7, v24
  s_bitcmp1_b32 s90, 29
  s_cbranch_scc1 L_p6_3
  s_bitcmp1_b32 s90, 21
  s_cbranch_scc1 L_p6_2
  s_bitcmp1_b32 s90, 13
  s_cbranch_scc1 L_p6_1
  s_bitcmp1_b32 s90, 5
  s_cbranch_scc1 L_p6_0
  s_waitcnt vmcnt(3)
L_p6_0:
  s_waitcnt vmcnt(4)
L_p6_1:
  s_waitcnt vmcnt(5)
L_p6_2:
  s_waitcnt vmcnt(6)
L_p6_3:
  s_waitcnt vmcnt(7)
  buffer_load_dwordx4 v[116:119], v0, s[20:23], s37 offen offset:1024 nt
  v_add_u32 v54, 2, v54
  ds_write_b32 v55, v54 offset:1536
  ds_read_b32 v53, v56 offset:528
  v_dot2_f32_bf16 v25, v84, v4, 0
  v_dot2_f32_bf16 v25, v85, v5, v25
  v_dot2_f32_bf16 v25, v86, v6, v25
  v_dot2_f32_bf16 v25, v87, v7, v25
  s_waitcnt lgkmcnt(0)
  v_readfirstlane_b32 s90, v53
  s_bitcmp1_b32 s90, 30
  s_cbranch_scc1 L_p7_3
  s_bitcmp1_b32 s90, 22
  s_cbranch_scc1 L_p7_2
  s_bitcmp1_b32 s90, 14
  s_cbranch_scc1 L_p7_1
  s_bitcmp1_b32 s90, 6
  s_cbranch_scc1 L_p7_0
  s_waitcnt vmcnt(3)
L_p7_0:
  s_waitcnt vmcnt(4)
L_p7_1:
  s_waitcnt vmcnt(5)
L_p7_2:
  s_waitcnt vmcnt(6)
L_p7_3:
  s_waitcnt vmcnt(7)
  buffer_load_dwordx4 v[120:123], v0, s[20:23], s37 offen offset:2048 nt
  v_dot2_f32_bf16 v26, v88, v4, 0
  v_dot2_f32_bf16 v26, v89, v5, v26
  v_dot2_f32_bf16 v26, v90, v6, v26
  v_dot2_f32_bf16 v26, v91, v7, v26
  s_bitcmp1_b32 s90, 31
  s_cbranch_scc1 L_p8_3
  s_bitcmp1_b32 s90, 23
  s_cbranch_scc1 L_p8_2
  s_bitcmp1_b32 s90, 15
  s_cbranch_scc1 L_p8_1
  s_bitcmp1_b32 s90, 7
  s_cbranch_scc1 L_p8_0
  s_waitcnt vmcnt(3)
L_p8_0:
  s_waitcnt vmcnt(4)
L_p8_1:
  s_waitcnt vmcnt(5)
L_p8_2:
  s_waitcnt vmcnt(6)
L_p8_3:
  s_waitcnt vmcnt(7)
  buffer_load_dwordx4 v[124:127], v0, s[20:23], s37 offen offset:3072 nt
  s_add_u32 s39, s39, 65536
  s_and_b32 s39, s39, 2097151
  s_add_u32 s37, s39, s87
  s_cmp_eq_u32 s38, 1
  s_cselect_b32 s20, s8, s20
  s_cselect_b32 s21, s9, s21
  v_add_u32 v54, 2, v54
  ds_write_b32 v55, v54 offset:1536
  ds_read_b32 v53, v56 offset:528
  v_dot2_f32_bf16 v27, v92, v4, 0
  v_dot2_f32_bf16 v27, v93, v5, v27
  v_dot2_f32_bf16 v27, v94, v6, v27
  v_dot2_f32_bf16 v27, v95, v7, v27
  s_waitcnt lgkmcnt(0)
  v_readfirstlane_b32 s90, v53
  s_bitcmp1_b32 s90, 24
  s_cbranch_scc1 L_p9_3
  s_bitcmp1_b32 s90, 16
  s_cbranch_scc1 L_p9_2
  s_bitcmp1_b32 s90, 8
  s_cbranch_scc1 L_p9_1
  s_bitcmp1_b32 s90, 0
  s_cbranch_scc1 L_p9_0
  s_waitcnt vmcnt(3)
L_p9_0:
  s_waitcnt vmcnt(4)
L_p9_1:
  s_waitcnt vmcnt(5)
L_p9_2:
  s_waitcnt vmcnt(6)
L_p9_3:
  s_waitcnt vmcnt(7)
  buffer_load_dwordx4 v[64:67], v0, s[20:23], s37 offen offset:0 nt
  v_dot2_f32_bf16 v28, v96, v4, 0
  v_dot2_f32_bf16 v28, v97, v5, v28
  v_dot2_f32_bf16 v28, v98, v6, v28
  v_dot2_f32_bf16 v28, v99, v7, v28
  s_bitcmp1_b32 s90, 25
  s_cbranch_scc1 L_p10_3
  s_bitcmp1_b32 s90, 17
  s_cbranch_scc1 L_p10_2
  s_bitcmp1_b32 s90, 9
  s_cbranch_scc1 L_p10_1
  s_bitcmp1_b32 s90, 1
  s_cbranch_scc1 L_p10_0
  s_waitcnt vmcnt(3)
L_p10_0:
  s_waitcnt vmcnt(4)
L_p10_1:
  s_waitcnt vmcnt(5)
L_p10_2:
  s_waitcnt vmcnt(6)
L_p10_3:
  s_waitcnt vmcnt(7)
  buffer_load_dwordx4 v[68:71], v0, s[20:23], s37 offen offset:1024 nt
  v_add_u32 v54, 2, v54
  ds_write_b32 v55, v54 offset:1536
  ds_read_b32 v53, v56 offset:528
  v_dot2_f32_bf16 v29, v100, v4, 0
  v_dot2_f32_bf16 v29, v101, v5, v29
  v_dot2_f32_bf16 v29, v102, v6, v29
  v_dot2_f32_bf16 v29, v103, v7, v29
  s_waitcnt lgkmcnt(0)
  v_readfirstlane_b32 s90, v53
  s_bitcmp1_b32 s90, 26
  s_cbranch_scc1 L_p11_3
  s_bitcmp1_b32 s90, 18
  s_cbranch_scc1 L_p11_2
  s_bitcmp1_b32 s90, 10
  s_cbranch_scc1 L_p11_1
  s_bitcmp1_b32 s90, 2
  s_cbranch_scc1 L_p11_0
  s_waitcnt vmcnt(3)
L_p11_0:
  s_waitcnt vmcnt(4)
L_p11_1:
  s_waitcnt vmcnt(5)
L_p11_2:
  s_waitcnt vmcnt(6)
L_p11_3:
  s_waitcnt vmcnt(7)
  buffer_load_dwordx4 v[72:75], v0, s[20:23], s37 offen offset:2048 nt
  v_dot2_f32_bf16 v30, v104, v4, 0
  v_dot2_f32_bf16 v30, v105, v5, v30
  v_dot2_f32_bf16 v30, v106, v6, v30
  v_dot2_f32_bf16 v30, v107, v7, v30
  s_bitcmp1_b32 s90, 27
  s_cbranch_scc1 L_p12_3
  s_bitcmp1_b32 s90, 19
  s_cbranch_scc1 L_p12_2
  s_bitcmp1_b32 s90, 11
  s_cbranch_scc1 L_p12_1
  s_bitcmp1_b32 s90, 3
  s_cbranch_scc1 L_p12_0
  s_waitcnt vmcnt(3)
L_p12_0:
  s_waitcnt vmcnt(4)
L_p12_1:
  s_waitcnt vmcnt(5)
L_p12_2:
  s_waitcnt vmcnt(6)
L_p12_3:
  s_waitcnt vmcnt(7)
  buffer_load_dwordx4 v[76:79], v0, s[20:23], s37 offen offset:3072 nt
  s_add_u32 s39, s39, 65536
  s_and_b32 s39, s39, 2097151
  s_add_u32 s37, s39, s87
  v_add_u32 v54, 2, v54
  ds_write_b32 v55, v54 offset:1536
  ds_read_b32 v53, v56 offset:528
  v_dot2_f32_bf16 v31, v108, v4, 0
  v_dot2_f32_bf16 v31, v109, v5, v31
  v_dot2_f32_bf16 v31, v110, v6, v31
  v_dot2_f32_bf16 v31, v111, v7, v31
  s_waitcnt lgkmcnt(0)
  v_readfirstlane_b32 s90, v53
  s_bitcmp1_b32 s90, 28
  s_cbranch_scc1 L_p13_3
  s_bitcmp1_b32 s90, 20
  s_cbranch_scc1 L_p13_2
  s_bitcmp1_b32 s90, 12
  s_cbranch_scc1 L_p13_1
  s_bitcmp1_b32 s90, 4
  s_cbranch_scc1 L_p13_0
  s_waitcnt vmcnt(3)
L_p13_0:
  s_waitcnt vmcnt(4)
L_p13_1:
  s_waitcnt vmcnt(5)
L_p13_2:
  s_waitcnt vmcnt(6)
L_p13_3:
  s_waitcnt vmcnt(7)
  buffer_load_dwordx4 v[80:83], v0, s[20:23], s37 offen offset:0 nt
  v_dot2_f32_bf16 v32, v112, v4, 0
  v_dot2_f32_bf16 v32, v113, v5, v32
  v_dot2_f32_bf16 v32, v114, v6, v32
  v_dot2_f32_bf16 v32, v115, v7, v32
  s_bitcmp1_b32 s90, 29
  s_cbranch_scc1 L_p14_3
  s_bitcmp1_b32 s90, 21
  s_cbranch_scc1 L_p14_2
  s_bitcmp1_b32 s90, 13
  s_cbranch_scc1 L_p14_1
  s_bitcmp1_b32 s90, 5
  s_cbranch_scc1 L_p14_0
  s_waitcnt vmcnt(3)
L_p14_0:
  s_waitcnt vmcnt(4)
L_p14_1:
  s_waitcnt vmcnt(5)
L_p14_2:
  s_waitcnt vmcnt(6)
L_p14_3:
  s_waitcnt vmcnt(7)
  buffer_load_dwordx4 v[84:87], v0, s[20:23], s37 offen offset:1024 nt
  v_add_u32 v54, 2, v54
  ds_write_b32 v55, v54 offset:1536
  ds_read_b32 v53, v56 offset:528
  v_dot2_f32_bf16 v33, v116, v4, 0
  v_dot2_f32_bf16 v33, v117, v5, v33
  v_dot2_f32_bf16 v33, v118, v6, v33
  v_dot2_f32_bf16 v33, v119, v7, v33
  s_waitcnt lgkmcnt(0)
  v_readfirstlane_b32 s90, v53
  s_bitcmp1_b32 s90, 30
  s_cbranch_scc1 L_p15_3
  s_bitcmp1_b32 s90, 22
  s_cbranch_scc1 L_p15_2
  s_bitcmp1_b32 s90, 14
  s_cbranch_scc1 L_p15_1
  s_bitcmp1_b32 s90, 6
  s_cbranch_scc1 L_p15_0
  s_waitcnt vmcnt(3)
L_p15_0:
  s_waitcnt vmcnt(4)
L_p15_1:
  s_waitcnt vmcnt(5)
L_p15_2:
  s_waitcnt vmcnt(6)
L_p15_3:
  s_waitcnt vmcnt(7)
  buffer_load_dwordx4 v[88:91], v0, s[20:23], s37 offen offset:2048 nt
  v_dot2_f32_bf16 v34, v120, v4, 0
  v_dot2_f32_bf16 v34, v121, v5, v34
  v_dot2_f32_bf16 v34, v122, v6, v34
  v_dot2_f32_bf16 v34, v123, v7, v34
  s_bitcmp1_b32 s90, 31
  s_cbranch_scc1 L_p16_3
  s_bitcmp1_b32 s90, 23
  s_cbranch_scc1 L_p16_2
  s_bitcmp1_b32 s90, 15
  s_cbranch_scc1 L_p16_1
  s_bitcmp1_b32 s90, 7
  s_cbranch_scc1 L_p16_0
  s_waitcnt vmcnt(3)
L_p16_0:
  s_waitcnt vmcnt(4)
L_p16_1:
  s_waitcnt vmcnt(5)
L_p16_2:
  s_waitcnt vmcnt(6)
L_p16_3:
  s_waitcnt vmcnt(7)
  buffer_load_dwordx4 v[92:95], v0, s[20:23], s37 offen offset:3072 nt
  s_add_u32 s39, s39, 65536
  s_and_b32 s39, s39, 2097151
  s_add_u32 s37, s39, s87
  v_add_u32 v54, 2, v54
  ds_write_b32 v55, v54 offset:1536
  ds_read_b32 v53, v56 offset:528
  v_dot2_f32_bf16 v35, v124, v4, 0
  v_dot2_f32_bf16 v35, v125, v5, v35
  v_dot2_f32_bf16 v35, v126, v6, v35
  v_dot2_f32_bf16 v35, v127, v7, v35
  v_mov_b32 v36, v37
  v_mov_b32 v37, v38
  v_mov_b32 v38, v39
  v_mov_b32 v39, v40
  v_mov_b32 v40, v41
  v_mov_b32 v41, v42
  v_mov_b32 v42, v43
  v_add_f32_dpp v20, v20, v20 row_ror:8 row_mask:0xf bank_mask:0x3
  v_add_f32_dpp v21, v21, v21 row_ror:8 row_mask:0xf bank_mask:0x3
  v_add_f32_dpp v22, v22, v22 row_ror:8 row_mask:0xf bank_mask:0x3
  v_add_f32_dpp v23, v23, v23 row_ror:8 row_mask:0xf bank_mask:0x3
  v_add_f32_dpp v24, v24, v24 row_ror:8 row_mask:0xf bank_mask:0x3
  v_add_f32_dpp v25, v25, v25 row_ror:8 row_mask:0xf bank_mask:0x3
  v_add_f32_dpp v26, v26, v26 row_ror:8 row_mask:0xf bank_mask:0x3
  v_add_f32_dpp v27, v27, v27 row_ror:8 row_mask:0xf bank_mask:0x3
  v_add_f32_dpp v20, v28, v28 row_ror:8 row_mask:0xf bank_mask:0xc
  v_add_f32_dpp v21, v29, v29 row_ror:8 row_mask:0xf bank_mask:0xc
  v_add_f32_dpp v22, v30, v30 row_ror:8 row_mask:0xf bank_mask:0xc
  v_add_f32_dpp v23, v31, v31 row_ror:8 row_mask:0xf bank_mask:0xc
  v_add_f32_dpp v24, v32, v32 row_ror:8 row_mask:0xf bank_mask:0xc
  v_add_f32_dpp v25, v33, v33 row_ror:8 row_mask:0xf bank_mask:0xc
  v_add_f32_dpp v26, v34, v34 row_ror:8 row_mask:0xf bank_mask:0xc
  v_add_f32_dpp v27, v35, v35 row_ror:8 row_mask:0xf bank_mask:0xc
  v_add_f32_dpp v20, v20, v20 row_half_mirror row_mask:0xf bank_mask:0x5
  v_add_f32_dpp v21, v21, v21 row_half_mirror row_mask:0xf bank_mask:0x5
  v_add_f32_dpp v22, v22, v22 row_half_mirror row_mask:0xf bank_mask:0x5
  v_add_f32_dpp v23, v23, v23 row_half_mirror row_mask:0xf bank_mask:0x5
  v_add_f32_dpp v20, v24, v24 row_half_mirror row_mask:0xf bank_mask:0xa
  v_add_f32_dpp v21, v25, v25 row_half_mirror row_mask:0xf bank_mask:0xa
  v_add_f32_dpp v22, v26, v26 row_half_mirror row_mask:0xf bank_mask:0xa
  v_add_f32_dpp v23, v27, v27 row_half_mirror row_mask:0xf bank_mask:0xa
  v_cndmask_b32 v29, v22, v20, s[48:49]
  v_cndmask_b32 v31, v23, v21, s[48:49]
  v_cndmask_b32 v28, v20, v22, s[48:49]
  v_cndmask_b32 v30, v21, v23, s[48:49]
  s_nop 0
  v_add_f32_dpp v20, v29, v28 quad_perm:[2,3,0,1] row_mask:0xf bank_mask:0xf
  v_add_f32_dpp v21, v31, v30 quad_perm:[2,3,0,1] row_mask:0xf bank_mask:0xf
  v_cndmask_b32 v29, v21, v20, s[50:51]
  v_cndmask_b32 v28, v20, v21, s[50:51]
  s_nop 1
  v_add_f32_dpp v20, v29, v28 quad_perm:[1,0,3,2] row_mask:0xf bank_mask:0xf
  v_mov_b32 v21, v20
  s_nop 1
  v_permlane16_swap_b32 v20, v21
  v_add_f32 v20, v20, v21
  v_cvt_pk_bf16_f32 v20, v20, v20
  v_and_b32 v43, 0xffff0000, v20
  s_sub_u32 s38, s38, 1
  s_cmp_lg_u32 s38, 0
  s_cbranch_scc1 L_kloop
  v_max3_f32 v44, v36, v37, v38
  v_max3_f32 v44, v44, v39, v40
  v_max3_f32 v44, v44, v41, v42
  v_max_f32 v44, v44, v43
  s_nop 1
  v_max_f32_dpp v44, v44, v44 quad_perm:[1,0,3,2] row_mask:0xf bank_mask:0xf
  s_nop 1
  v_max_f32_dpp v44, v44, v44 quad_perm:[2,3,0,1] row_mask:0xf bank_mask:0xf
  s_nop 1
  v_max_f32_dpp v44, v44, v44 row_half_mirror row_mask:0xf bank_mask:0xf
  s_nop 1
  v_max_f32_dpp v44, v44, v44 row_mirror row_mask:0xf bank_mask:0xf
  v_mov_b32 v45, v44
  s_nop 1
  v_permlane32_swap_b32 v44, v45
  v_max_f32 v44, v44, v45
  v_mul_f32 v48, s69, v44
  v_fma_f32 v36, v36, s69, -v48
  v_fma_f32 v37, v37, s69, -v48
  v_fma_f32 v38, v38, s69, -v48
  v_fma_f32 v39, v39, s69, -v48
  v_fma_f32 v40, v40, s69, -v48
  v_fma_f32 v41, v41, s69, -v48
  v_fma_f32 v42, v42, s69, -v48
  v_fma_f32 v43, v43, s69, -v48
  v_exp_f32 v36, v36
  v_exp_f32 v37, v37
  v_exp_f32 v38, v38
  v_exp_f32 v39, v39
  v_exp_f32 v40, v40
  v_exp_f32 v41, v41
  v_exp_f32 v42, v42
  v_exp_f32 v43, v43
  v_add_f32 v50, v36, v37
  v_add_f32 v50, v50, v38
  v_add_f32 v50, v50, v39
  v_add_f32 v50, v50, v40
  v_add_f32 v50, v50, v41
  v_add_f32 v50, v50, v42
  v_add_f32 v50, v50, v43
  v_cvt_pk_bf16_f32 v36, v36, v36
  v_cvt_pk_bf16_f32 v37, v37, v37
  v_cvt_pk_bf16_f32 v38, v38, v38
  v_cvt_pk_bf16_f32 v39, v39, v39
  v_cvt_pk_bf16_f32 v40, v40, v40
  v_cvt_pk_bf16_f32 v41, v41, v41
  v_cvt_pk_bf16_f32 v42, v42, v42
  v_cvt_pk_bf16_f32 v43, v43, v43
  s_nop 1
  v_add_f32_dpp v50, v50, v50 quad_perm:[1,0,3,2] row_mask:0xf bank_mask:0xf
  s_nop 1
  v_add_f32_dpp v50, v50, v50 quad_perm:[2,3,0,1] row_mask:0xf bank_mask:0xf
  s_nop 1
  v_add_f32_dpp v50, v50, v50 row_half_mirror row_mask:0xf bank_mask:0xf
  s_nop 1
  v_add_f32_dpp v50, v50, v50 row_mirror row_mask:0xf bank_mask:0xf
  v_mov_b32 v45, v50
  s_nop 1
  v_permlane32_swap_b32 v50, v45
  v_add_f32 v50, v50, v45
  v_mov_b32 v49, 1
  v_mov_b32 v51, 1
  v_lshlrev_b32 v45, 2, v56
  ds_write_b128 v45, v[48:51] offset:576
  s_mov_b32 s38, 8
L_vloop:
  v_and_b32_dpp v12, v36, v8 row_newbcast:0 row_mask:0xf bank_mask:0xf
  v_and_b32_dpp v13, v36, v9 row_newbcast:0 row_mask:0xf bank_mask:0xf
  v_and_b32_dpp v14, v36, v10 row_newbcast:0 row_mask:0xf bank_mask:0xf
  v_and_b32_dpp v15, v36, v11 row_newbcast:0 row_mask:0xf bank_mask:0xf
  s_waitcnt lgkmcnt(0)
  v_readfirstlane_b32 s90, v53
  s_bitcmp1_b32 s90, 24
  s_cbranch_scc1 L_p17_3
  s_bitcmp1_b32 s90, 16
  s_cbranch_scc1 L_p17_2
  s_bitcmp1_b32 s90, 8
  s_cbranch_scc1 L_p17_1
  s_bitcmp1_b32 s90, 0
  s_cbranch_scc1 L_p17_0
  s_waitcnt vmcnt(3)
L_p17_0:
  s_waitcnt vmcnt(4)
L_p17_1:
  s_waitcnt vmcnt(5)
L_p17_2:
  s_waitcnt vmcnt(6)
L_p17_3:
  s_waitcnt vmcnt(7)
  buffer_load_dwordx4 v[96:99], v0, s[20:23], s37 offen offset:0 nt
  v_mfma_f32_16x16x32_bf16 v[16:19], v[12:15], v[64:67], v[16:19]
  v_and_b32_dpp v12, v36, v8 row_newbcast:1 row_mask:0xf bank_mask:0xf
  v_and_b32_dpp v13, v36, v9 row_newbcast:1 row_mask:0xf bank_mask:0xf
  v_and_b32_dpp v14, v36, v10 row_newbcast:1 row_mask:0xf bank_mask:0xf
  v_and_b32_dpp v15, v36, v11 row_newbcast:1 row_mask:0xf bank_mask:0xf
  s_bitcmp1_b32 s90, 25
  s_cbranch_scc1 L_p18_3
  s_bitcmp1_b32 s90, 17
  s_cbranch_scc1 L_p18_2
  s_bitcmp1_b32 s90, 9
  s_cbranch_scc1 L_p18_1
  s_bitcmp1_b32 s90, 1
  s_cbranch_scc1 L_p18_0
  s_waitcnt vmcnt(3)
L_p18_0:
  s_waitcnt vmcnt(4)
L_p18_1:
  s_waitcnt vmcnt(5)
L_p18_2:
  s_waitcnt vmcnt(6)
L_p18_3:
  s_waitcnt vmcnt(7)
  buffer_load_dwordx4 v[100:103], v0, s[20:23], s37 offen offset:1024 nt
  v_mfma_f32_16x16x32_bf16 v[16:19], v[12:15], v[68:71], v[16:19]
  v_add_u32 v54, 2, v54
  ds_write_b32 v55, v54 offset:1536
  ds_read_b32 v53, v56 offset:528
  v_and_b32_dpp v12, v36, v8 row_newbcast:2 row_mask:0xf bank_mask:0xf
  v_and_b32_dpp v13, v36, v9 row_newbcast:2 row_mask:0xf bank_mask:0xf
  v_and_b32_dpp v14, v36, v10 row_newbcast:2 row_mask:0xf bank_mask:0xf
  v_and_b32_dpp v15, v36, v11 row_newbcast:2 row_mask:0xf bank_mask:0xf
  s_waitcnt lgkmcnt(0)
  v_readfirstlane_b32 s90, v53
  s_bitcmp1_b32 s90, 26
  s_cbranch_scc1 L_p19_3
  s_bitcmp1_b32 s90, 18
  s_cbranch_scc1 L_p19_2
  s_bitcmp1_b32 s90, 10
  s_cbranch_scc1 L_p19_1
  s_bitcmp1_b32 s90, 2
  s_cbranch_scc1 L_p19_0
  s_waitcnt vmcnt(3)
L_p19_0:
  s_waitcnt vmcnt(4)
L_p19_1:
  s_waitcnt vmcnt(5)
L_p19_2:
  s_waitcnt vmcnt(6)
L_p19_3:
  s_waitcnt vmcnt(7)
  buffer_load_dwordx4 v[104:107], v0, s[20:23], s37 offen offset:2048 nt
  v_mfma_f32_16x16x32_bf16 v[16:19], v[12:15], v[72:75], v[16:19]
  v_and_b32_dpp v12, v36, v8 row_newbcast:3 row_mask:0xf bank_mask:0xf
  v_and_b32_dpp v13, v36, v9 row_newbcast:3 row_mask:0xf bank_mask:0xf
  v_and_b32_dpp v14, v36, v10 row_newbcast:3 row_mask:0xf bank_mask:0xf
  v_and_b32_dpp v15, v36, v11 row_newbcast:3 row_mask:0xf bank_mask:0xf
  s_bitcmp1_b32 s90, 27
  s_cbranch_scc1 L_p20_3
  s_bitcmp1_b32 s90, 19
  s_cbranch_scc1 L_p20_2
  s_bitcmp1_b32 s90, 11
  s_cbranch_scc1 L_p20_1
  s_bitcmp1_b32 s90, 3
  s_cbranch_scc1 L_p20_0
  s_waitcnt vmcnt(3)
L_p20_0:
  s_waitcnt vmcnt(4)
L_p20_1:
  s_waitcnt vmcnt(5)
L_p20_2:
  s_waitcnt vmcnt(6)
L_p20_3:
  s_waitcnt vmcnt(7)
  buffer_load_dwordx4 v[108:111], v0, s[20:23], s37 offen offset:3072 nt
  s_add_u32 s39, s39, 65536
  s_and_b32 s39, s39, 2097151
  s_add_u32 s37, s39, s87
  v_mfma_f32_16x16x32_bf16 v[16:19], v[12:15], v[76:79], v[16:19]
  v_add_u32 v54, 2, v54
  ds_write_b32 v55, v54 offset:1536
  ds_read_b32 v53, v56 offset:528
  v_and_b32_dpp v12, v36, v8 row_newbcast:4 row_mask:0xf bank_mask:0xf
  v_and_b32_dpp v13, v36, v9 row_newbcast:4 row_mask:0xf bank_mask:0xf
  v_and_b32_dpp v14, v36, v10 row_newbcast:4 row_mask:0xf bank_mask:0xf
  v_and_b32_dpp v15, v36, v11 row_newbcast:4 row_mask:0xf bank_mask:0xf
  s_waitcnt lgkmcnt(0)
  v_readfirstlane_b32 s90, v53
  s_bitcmp1_b32 s90, 28
  s_cbranch_scc1 L_p21_3
  s_bitcmp1_b32 s90, 20
  s_cbranch_scc1 L_p21_2
  s_bitcmp1_b32 s90, 12
  s_cbranch_scc1 L_p21_1
  s_bitcmp1_b32 s90, 4
  s_cbranch_scc1 L_p21_0
  s_waitcnt vmcnt(3)
L_p21_0:
  s_waitcnt vmcnt(4)
L_p21_1:
  s_waitcnt vmcnt(5)
L_p21_2:
  s_waitcnt vmcnt(6)
L_p21_3:
  s_waitcnt vmcnt(7)
  buffer_load_dwordx4 v[112:115], v0, s[20:23], s37 offen offset:0 nt
  v_mfma_f32_16x16x32_bf16 v[16:19], v[12:15], v[80:83], v[16:19]
  v_and_b32_dpp v12, v36, v8 row_newbcast:5 row_mask:0xf bank_mask:0xf
  v_and_b32_dpp v13, v36, v9 row_newbcast:5 row_mask:0xf bank_mask:0xf
  v_and_b32_dpp v14, v36, v10 row_newbcast:5 row_mask:0xf bank_mask:0xf
  v_and_b32_dpp v15, v36, v11 row_newbcast:5 row_mask:0xf bank_mask:0xf
  s_bitcmp1_b32 s90, 29
  s_cbranch_scc1 L_p22_3
  s_bitcmp1_b32 s90, 21
  s_cbranch_scc1 L_p22_2
  s_bitcmp1_b32 s90, 13
  s_cbranch_scc1 L_p22_1
  s_bitcmp1_b32 s90, 5
  s_cbranch_scc1 L_p22_0
  s_waitcnt vmcnt(3)
L_p22_0:
  s_waitcnt vmcnt(4)
L_p22_1:
  s_waitcnt vmcnt(5)
L_p22_2:
  s_waitcnt vmcnt(6)
L_p22_3:
  s_waitcnt vmcnt(7)
  buffer_load_dwordx4 v[116:119], v0, s[20:23], s37 offen offset:1024 nt
  v_mfma_f32_16x16x32_bf16 v[16:19], v[12:15], v[84:87], v[16:19]
  v_add_u32 v54, 2, v54
  ds_write_b32 v55, v54 offset:1536
  ds_read_b32 v53, v56 offset:528
  v_and_b32_dpp v12, v36, v8 row_newbcast:6 row_mask:0xf bank_mask:0xf
  v_and_b32_dpp v13, v36, v9 row_newbcast:6 row_mask:0xf bank_mask:0xf
  v_and_b32_dpp v14, v36, v10 row_newbcast:6 row_mask:0xf bank_mask:0xf
  v_and_b32_dpp v15, v36, v11 row_newbcast:6 row_mask:0xf bank_mask:0xf
  s_waitcnt lgkmcnt(0)
  v_readfirstlane_b32 s90, v53
  s_bitcmp1_b32 s90, 30
  s_cbranch_scc1 L_p23_3
  s_bitcmp1_b32 s90, 22
  s_cbranch_scc1 L_p23_2
  s_bitcmp1_b32 s90, 14
  s_cbranch_scc1 L_p23_1
  s_bitcmp1_b32 s90, 6
  s_cbranch_scc1 L_p23_0
  s_waitcnt vmcnt(3)
L_p23_0:
  s_waitcnt vmcnt(4)
L_p23_1:
  s_waitcnt vmcnt(5)
L_p23_2:
  s_waitcnt vmcnt(6)
L_p23_3:
  s_waitcnt vmcnt(7)
  buffer_load_dwordx4 v[120:123], v0, s[20:23], s37 offen offset:2048 nt
  v_mfma_f32_16x16x32_bf16 v[16:19], v[12:15], v[88:91], v[16:19]
  v_and_b32_dpp v12, v36, v8 row_newbcast:7 row_mask:0xf bank_mask:0xf
  v_and_b32_dpp v13, v36, v9 row_newbcast:7 row_mask:0xf bank_mask:0xf
  v_and_b32_dpp v14, v36, v10 row_newbcast:7 row_mask:0xf bank_mask:0xf
  v_and_b32_dpp v15, v36, v11 row_newbcast:7 row_mask:0xf bank_mask:0xf
  s_bitcmp1_b32 s90, 31
  s_cbranch_scc1 L_p24_3
  s_bitcmp1_b32 s90, 23
  s_cbranch_scc1 L_p24_2
  s_bitcmp1_b32 s90, 15
  s_cbranch_scc1 L_p24_1
  s_bitcmp1_b32 s90, 7
  s_cbranch_scc1 L_p24_0
  s_waitcnt vmcnt(3)
L_p24_0:
  s_waitcnt vmcnt(4)
L_p24_1:
  s_waitcnt vmcnt(5)
L_p24_2:
  s_waitcnt vmcnt(6)
L_p24_3:
  s_waitcnt vmcnt(7)
  buffer_load_dwordx4 v[124:127], v0, s[20:23], s37 offen offset:3072 nt
  s_add_u32 s39, s39, 65536
  s_and_b32 s39, s39, 2097151
  s_add_u32 s37, s39, s87
  v_mfma_f32_16x16x32_bf16 v[16:19], v[12:15], v[92:95], v[16:19]
  v_add_u32 v54, 2, v54
  ds_write_b32 v55, v54 offset:1536
  ds_read_b32 v53, v56 offset:528
  s_sub_u32 s38, s38, 1
  s_cmp_eq_u32 s38, 0
  s_cbranch_scc1 L_drain
  v_and_b32_dpp v12, v36, v8 row_newbcast:8 row_mask:0xf bank_mask:0xf
  v_and_b32_dpp v13, v36, v9 row_newbcast:8 row_mask:0xf bank_mask:0xf
  v_and_b32_dpp v14, v36, v10 row_newbcast:8 row_mask:0xf bank_mask:0xf
  v_and_b32_dpp v15, v36, v11 row_newbcast:8 row_mask:0xf bank_mask:0xf
  s_waitcnt lgkmcnt(0)
  v_readfirstlane_b32 s90, v53
  s_bitcmp1_b32 s90, 24
  s_cbranch_scc1 L_p25_3
  s_bitcmp1_b32 s90, 16
  s_cbranch_scc1 L_p25_2
  s_bitcmp1_b32 s90, 8
  s_cbranch_scc1 L_p25_1
  s_bitcmp1_b32 s90, 0
  s_cbranch_scc1 L_p25_0
  s_waitcnt vmcnt(3)
L_p25_0:
  s_waitcnt vmcnt(4)
L_p25_1:
  s_waitcnt vmcnt(5)
L_p25_2:
  s_waitcnt vmcnt(6)
L_p25_3:
  s_waitcnt vmcnt(7)
  buffer_load_dwordx4 v[64:67], v0, s[20:23], s37 offen offset:0 nt
  v_mfma_f32_16x16x32_bf16 v[16:19], v[12:15], v[96:99], v[16:19]
  v_and_b32_dpp v12, v36, v8 row_newbcast:9 row_mask:0xf bank_mask:0xf
  v_and_b32_dpp v13, v36, v9 row_newbcast:9 row_mask:0xf bank_mask:0xf
  v_and_b32_dpp v14, v36, v10 row_newbcast:9 row_mask:0xf bank_mask:0xf
  v_and_b32_dpp v15, v36, v11 row_newbcast:9 row_mask:0xf bank_mask:0xf
  s_bitcmp1_b32 s90, 25
  s_cbranch_scc1 L_p26_3
  s_bitcmp1_b32 s90, 17
  s_cbranch_scc1 L_p26_2
  s_bitcmp1_b32 s90, 9
  s_cbranch_scc1 L_p26_1
  s_bitcmp1_b32 s90, 1
  s_cbranch_scc1 L_p26_0
  s_waitcnt vmcnt(3)
L_p26_0:
  s_waitcnt vmcnt(4)
L_p26_1:
  s_waitcnt vmcnt(5)
L_p26_2:
  s_waitcnt vmcnt(6)
L_p26_3:
  s_waitcnt vmcnt(7)
  buffer_load_dwordx4 v[68:71], v0, s[20:23], s37 offen offset:1024 nt
  v_mfma_f32_16x16x32_bf16 v[16:19], v[12:15], v[100:103], v[16:19]
  v_add_u32 v54, 2, v54
  ds_write_b32 v55, v54 offset:1536
  ds_read_b32 v53, v56 offset:528
  v_and_b32_dpp v12, v36, v8 row_newbcast:10 row_mask:0xf bank_mask:0xf
  v_and_b32_dpp v13, v36, v9 row_newbcast:10 row_mask:0xf bank_mask:0xf
  v_and_b32_dpp v14, v36, v10 row_newbcast:10 row_mask:0xf bank_mask:0xf
  v_and_b32_dpp v15, v36, v11 row_newbcast:10 row_mask:0xf bank_mask:0xf
  s_waitcnt lgkmcnt(0)
  v_readfirstlane_b32 s90, v53
  s_bitcmp1_b32 s90, 26
  s_cbranch_scc1 L_p27_3
  s_bitcmp1_b32 s90, 18
  s_cbranch_scc1 L_p27_2
  s_bitcmp1_b32 s90, 10
  s_cbranch_scc1 L_p27_1
  s_bitcmp1_b32 s90, 2
  s_cbranch_scc1 L_p27_0
  s_waitcnt vmcnt(3)
L_p27_0:
  s_waitcnt vmcnt(4)
L_p27_1:
  s_waitcnt vmcnt(5)
L_p27_2:
  s_waitcnt vmcnt(6)
L_p27_3:
  s_waitcnt vmcnt(7)
  buffer_load_dwordx4 v[72:75], v0, s[20:23], s37 offen offset:2048 nt
  v_mfma_f32_16x16x32_bf16 v[16:19], v[12:15], v[104:107], v[16:19]
  v_and_b32_dpp v12, v36, v8 row_newbcast:11 row_mask:0xf bank_mask:0xf
  v_and_b32_dpp v13, v36, v9 row_newbcast:11 row_mask:0xf bank_mask:0xf
  v_and_b32_dpp v14, v36, v10 row_newbcast:11 row_mask:0xf bank_mask:0xf
  v_and_b32_dpp v15, v36, v11 row_newbcast:11 row_mask:0xf bank_mask:0xf
  s_bitcmp1_b32 s90, 27
  s_cbranch_scc1 L_p28_3
  s_bitcmp1_b32 s90, 19
  s_cbranch_scc1 L_p28_2
  s_bitcmp1_b32 s90, 11
  s_cbranch_scc1 L_p28_1
  s_bitcmp1_b32 s90, 3
  s_cbranch_scc1 L_p28_0
  s_waitcnt vmcnt(3)
L_p28_0:
  s_waitcnt vmcnt(4)
L_p28_1:
  s_waitcnt vmcnt(5)
L_p28_2:
  s_waitcnt vmcnt(6)
L_p28_3:
  s_waitcnt vmcnt(7)
  buffer_load_dwordx4 v[76:79], v0, s[20:23], s37 offen offset:3072 nt
  s_add_u32 s39, s39, 65536
  s_and_b32 s39, s39, 2097151
  s_add_u32 s37, s39, s87
  v_mfma_f32_16x16x32_bf16 v[16:19], v[12:15], v[108:111], v[16:19]
  v_add_u32 v54, 2, v54
  ds_write_b32 v55, v54 offset:1536
  ds_read_b32 v53, v56 offset:528
  v_and_b32_dpp v12, v36, v8 row_newbcast:12 row_mask:0xf bank_mask:0xf
  v_and_b32_dpp v13, v36, v9 row_newbcast:12 row_mask:0xf bank_mask:0xf
  v_and_b32_dpp v14, v36, v10 row_newbcast:12 row_mask:0xf bank_mask:0xf
  v_and_b32_dpp v15, v36, v11 row_newbcast:12 row_mask:0xf bank_mask:0xf
  s_waitcnt lgkmcnt(0)
  v_readfirstlane_b32 s90, v53
  s_bitcmp1_b32 s90, 28
  s_cbranch_scc1 L_p29_3
  s_bitcmp1_b32 s90, 20
  s_cbranch_scc1 L_p29_2
  s_bitcmp1_b32 s90, 12
  s_cbranch_scc1 L_p29_1
  s_bitcmp1_b32 s90, 4
  s_cbranch_scc1 L_p29_0
  s_waitcnt vmcnt(3)
L_p29_0:
  s_waitcnt vmcnt(4)
L_p29_1:
  s_waitcnt vmcnt(5)
L_p29_2:
  s_waitcnt vmcnt(6)
L_p29_3:
  s_waitcnt vmcnt(7)
  buffer_load_dwordx4 v[80:83], v0, s[20:23], s37 offen offset:0 nt
  v_mfma_f32_16x16x32_bf16 v[16:19], v[12:15], v[112:115], v[16:19]
  v_and_b32_dpp v12, v36, v8 row_newbcast:13 row_mask:0xf bank_mask:0xf
  v_and_b32_dpp v13, v36, v9 row_newbcast:13 row_mask:0xf bank_mask:0xf
  v_and_b32_dpp v14, v36, v10 row_newbcast:13 row_mask:0xf bank_mask:0xf
  v_and_b32_dpp v15, v36, v11 row_newbcast:13 row_mask:0xf bank_mask:0xf
  s_bitcmp1_b32 s90, 29
  s_cbranch_scc1 L_p30_3
  s_bitcmp1_b32 s90, 21
  s_cbranch_scc1 L_p30_2
  s_bitcmp1_b32 s90, 13
  s_cbranch_scc1 L_p30_1
  s_bitcmp1_b32 s90, 5
  s_cbranch_scc1 L_p30_0
  s_waitcnt vmcnt(3)
L_p30_0:
  s_waitcnt vmcnt(4)
L_p30_1:
  s_waitcnt vmcnt(5)
L_p30_2:
  s_waitcnt vmcnt(6)
L_p30_3:
  s_waitcnt vmcnt(7)
  buffer_load_dwordx4 v[84:87], v0, s[20:23], s37 offen offset:1024 nt
  v_mfma_f32_16x16x32_bf16 v[16:19], v[12:15], v[116:119], v[16:19]
  v_add_u32 v54, 2, v54
  ds_write_b32 v55, v54 offset:1536
  ds_read_b32 v53, v56 offset:528
  v_and_b32_dpp v12, v36, v8 row_newbcast:14 row_mask:0xf bank_mask:0xf
  v_and_b32_dpp v13, v36, v9 row_newbcast:14 row_mask:0xf bank_mask:0xf
  v_and_b32_dpp v14, v36, v10 row_newbcast:14 row_mask:0xf bank_mask:0xf
  v_and_b32_dpp v15, v36, v11 row_newbcast:14 row_mask:0xf bank_mask:0xf
  s_waitcnt lgkmcnt(0)
  v_readfirstlane_b32 s90, v53
  s_bitcmp1_b32 s90, 30
  s_cbranch_scc1 L_p31_3
  s_bitcmp1_b32 s90, 22
  s_cbranch_scc1 L_p31_2
  s_bitcmp1_b32 s90, 14
  s_cbranch_scc1 L_p31_1
  s_bitcmp1_b32 s90, 6
  s_cbranch_scc1 L_p31_0
  s_waitcnt vmcnt(3)
L_p31_0:
  s_waitcnt vmcnt(4)
L_p31_1:
  s_waitcnt vmcnt(5)
L_p31_2:
  s_waitcnt vmcnt(6)
L_p31_3:
  s_waitcnt vmcnt(7)
  buffer_load_dwordx4 v[88:91], v0, s[20:23], s37 offen offset:2048 nt
  v_mfma_f32_16x16x32_bf16 v[16:19], v[12:15], v[120:123], v[16:19]
  v_and_b32_dpp v12, v36, v8 row_newbcast:15 row_mask:0xf bank_mask:0xf
  v_and_b32_dpp v13, v36, v9 row_newbcast:15 row_mask:0xf bank_mask:0xf
  v_and_b32_dpp v14, v36, v10 row_newbcast:15 row_mask:0xf bank_mask:0xf
  v_and_b32_dpp v15, v36, v11 row_newbcast:15 row_mask:0xf bank_mask:0xf
  s_bitcmp1_b32 s90, 31
  s_cbranch_scc1 L_p32_3
  s_bitcmp1_b32 s90, 23
  s_cbranch_scc1 L_p32_2
  s_bitcmp1_b32 s90, 15
  s_cbranch_scc1 L_p32_1
  s_bitcmp1_b32 s90, 7
  s_cbranch_scc1 L_p32_0
  s_waitcnt vmcnt(3)
L_p32_0:
  s_waitcnt vmcnt(4)
L_p32_1:
  s_waitcnt vmcnt(5)
L_p32_2:
  s_waitcnt vmcnt(6)
L_p32_3:
  s_waitcnt vmcnt(7)
  buffer_load_dwordx4 v[92:95], v0, s[20:23], s37 offen offset:3072 nt
  s_add_u32 s39, s39, 65536
  s_and_b32 s39, s39, 2097151
  s_add_u32 s37, s39, s87
  v_mfma_f32_16x16x32_bf16 v[16:19], v[12:15], v[124:127], v[16:19]
  v_add_u32 v54, 2, v54
  ds_write_b32 v55, v54 offset:1536
  ds_read_b32 v53, v56 offset:528
  v_mov_b32 v36, v37
  v_mov_b32 v37, v38
  v_mov_b32 v38, v39
  v_mov_b32 v39, v40
  v_mov_b32 v40, v41
  v_mov_b32 v41, v42
  v_mov_b32 v42, v43
  s_branch L_vloop
L_drain:
  v_mov_b32 v63, 0
  s_waitcnt vmcnt(7)
  v_mov_b32 v54, 224
  ds_write_b32 v55, v54 offset:1536
  s_mov_b32 s68, 16777216
L_parw:
  ds_read_b128 v[164:167], v63 offset:656
  ds_read_b128 v[160:163], v63 offset:640
  s_sub_u32 s68, s68, 1
  s_cmp_eq_u32 s68, 0
  s_waitcnt lgkmcnt(0)
  s_cbranch_scc1 L_parok
  v_cmp_eq_u32 vcc, 0, v166
  s_cbranch_vccnz L_parw
L_parok:
  v_readfirstlane_b32 s86, v164
  v_readfirstlane_b32 s89, v165
  v_and_b32_dpp v128, v36, v8 row_newbcast:8 row_mask:0xf bank_mask:0xf
  v_and_b32_dpp v129, v36, v9 row_newbcast:8 row_mask:0xf bank_mask:0xf
  v_and_b32_dpp v130, v36, v10 row_newbcast:8 row_mask:0xf bank_mask:0xf
  v_and_b32_dpp v131, v36, v11 row_newbcast:8 row_mask:0xf bank_mask:0xf
  v_and_b32_dpp v132, v36, v8 row_newbcast:9 row_mask:0xf bank_mask:0xf
  v_and_b32_dpp v133, v36, v9 row_newbcast:9 row_mask:0xf bank_mask:0xf
  v_and_b32_dpp v134, v36, v10 row_newbcast:9 row_mask:0xf bank_mask:0xf
  v_and_b32_dpp v135, v36, v11 row_newbcast:9 row_mask:0xf bank_mask:0xf
  v_and_b32_dpp v136, v36, v8 row_newbcast:10 row_mask:0xf bank_mask:0xf
  v_and_b32_dpp v137, v36, v9 row_newbcast:10 row_mask:0xf bank_mask:0xf
  v_and_b32_dpp v138, v36, v10 row_newbcast:10 row_mask:0xf bank_mask:0xf
  v_and_b32_dpp v139, v36, v11 row_newbcast:10 row_mask:0xf bank_mask:0xf
  v_and_b32_dpp v140, v36, v8 row_newbcast:11 row_mask:0xf bank_mask:0xf
  v_and_b32_dpp v141, v36, v9 row_newbcast:11 row_mask:0xf bank_mask:0xf
  v_and_b32_dpp v142, v36, v10 row_newbcast:11 row_mask:0xf bank_mask:0xf
  v_and_b32_dpp v143, v36, v11 row_newbcast:11 row_mask:0xf bank_mask:0xf
  v_and_b32_dpp v144, v36, v8 row_newbcast:12 row_mask:0xf bank_mask:0xf
  v_and_b32_dpp v145, v36, v9 row_newbcast:12 row_mask:0xf bank_mask:0xf
  v_and_b32_dpp v146, v36, v10 row_newbcast:12 row_mask:0xf bank_mask:0xf
  v_and_b32_dpp v147, v36, v11 row_newbcast:12 row_mask:0xf bank_mask:0xf
  v_and_b32_dpp v148, v36, v8 row_newbcast:13 row_mask:0xf bank_mask:0xf
  v_and_b32_dpp v149, v36, v9 row_newbcast:13 row_mask:0xf bank_mask:0xf
  v_and_b32_dpp v150, v36, v10 row_newbcast:13 row_mask:0xf bank_mask:0xf
  v_and_b32_dpp v151, v36, v11 row_newbcast:13 row_mask:0xf bank_mask:0xf
  v_and_b32_dpp v152, v36, v8 row_newbcast:14 row_mask:0xf bank_mask:0xf
  v_and_b32_dpp v153, v36, v9 row_newbcast:14 row_mask:0xf bank_mask:0xf
  v_and_b32_dpp v154, v36, v10 row_newbcast:14 row_mask:0xf bank_mask:0xf
  v_and_b32_dpp v155, v36, v11 row_newbcast:14 row_mask:0xf bank_mask:0xf
  v_and_b32_dpp v156, v36, v8 row_newbcast:15 row_mask:0xf bank_mask:0xf
  v_and_b32_dpp v157, v36, v9 row_newbcast:15 row_mask:0xf bank_mask:0xf
  v_and_b32_dpp v158, v36, v10 row_newbcast:15 row_mask:0xf bank_mask:0xf
  v_and_b32_dpp v159, v36, v11 row_newbcast:15 row_mask:0xf bank_mask:0xf
  s_bfe_u32 s40, s86, 0x80000
  s_bfe_u32 s41, s86, 0x80008
  s_bfe_u32 s42, s86, 0x80010
  s_bfe_u32 s43, s86, 0x80018
  v_add_u32 v57, v57, v167
  s_mov_b32 s68, 1048576
  s_cmp_eq_u32 s89, 0
  s_waitcnt vmcnt(7)
  v_mfma_f32_16x16x32_bf16 v[16:19], v[128:131], v[96:99], v[16:19]
  s_waitcnt vmcnt(6)
  v_mfma_f32_16x16x32_bf16 v[16:19], v[132:135], v[100:103], v[16:19]
  s_waitcnt vmcnt(5)
  v_mfma_f32_16x16x32_bf16 v[16:19], v[136:139], v[104:107], v[16:19]
  s_waitcnt vmcnt(4)
  v_mfma_f32_16x16x32_bf16 v[16:19], v[140:143], v[108:111], v[16:19]
  s_waitcnt vmcnt(3)
  v_mfma_f32_16x16x32_bf16 v[16:19], v[144:147], v[112:115], v[16:19]
  s_waitcnt vmcnt(2)
  v_mfma_f32_16x16x32_bf16 v[16:19], v[148:151], v[116:119], v[16:19]
  s_waitcnt vmcnt(1)
  v_mfma_f32_16x16x32_bf16 v[16:19], v[152:155], v[120:123], v[16:19]
  s_waitcnt vmcnt(0)
  v_mfma_f32_16x16x32_bf16 v[16:19], v[156:159], v[124:127], v[16:19]
  s_nop 7
  ds_write_b128 v61, v[16:19] offset:2560
  ds_add_rtn_u32 v191, v60, v62 offset:768
  ds_read_b128 v[168:171], v0 offset:2560
  ds_read_b128 v[172:175], v0 offset:3584
  ds_read_b128 v[176:179], v0 offset:4608
  ds_read_b128 v[180:183], v0 offset:5632
  s_waitcnt lgkmcnt(4)
  v_cmp_eq_u32 vcc, 3, v191
  s_cbranch_vccz L_notlast
  s_waitcnt lgkmcnt(3)
  v_pk_mul_f32 v[16:17], v[168:169], v[160:161] op_sel:[0,0] op_sel_hi:[1,0]
  v_pk_mul_f32 v[18:19], v[170:171], v[160:161] op_sel:[0,0] op_sel_hi:[1,0]
  s_waitcnt lgkmcnt(2)
  v_pk_fma_f32 v[16:17], v[172:173], v[160:161], v[16:17] op_sel:[0,1,0] op_sel_hi:[1,1,1]
  v_pk_fma_f32 v[18:19], v[174:175], v[160:161], v[18:19] op_sel:[0,1,0] op_sel_hi:[1,1,1]
  s_waitcnt lgkmcnt(1)
  v_pk_fma_f32 v[16:17], v[176:177], v[162:163], v[16:17] op_sel:[0,0,0] op_sel_hi:[1,0,1]
  v_pk_fma_f32 v[18:19], v[178:179], v[162:163], v[18:19] op_sel:[0,0,0] op_sel_hi:[1,0,1]
  s_waitcnt lgkmcnt(0)
  v_pk_fma_f32 v[16:17], v[180:181], v[162:163], v[16:17] op_sel:[0,1,0] op_sel_hi:[1,1,1]
  v_pk_fma_f32 v[18:19], v[182:183], v[162:163], v[18:19] op_sel:[0,1,0] op_sel_hi:[1,1,1]
  v_perm_b32 v16, v16, v164, s44
  v_perm_b32 v17, v17, v164, s45
  v_perm_b32 v18, v18, v164, s46
  v_perm_b32 v19, v19, v164, s47
  s_cbranch_scc1 L_wt33
  buffer_store_dwordx4 v[16:19], v0, s[24:27], s65 offen
  s_branch L_wd33
L_wt33:
  buffer_store_dwordx4 v[16:19], v0, s[24:27], s65 offen sc1
L_wd33:
L_notlast:
  s_cmp_eq_u32 s93, 99
  s_cbranch_scc1 L_fin
  s_cmp_ge_u32 s93, 14
  s_barrier
  s_cbranch_scc1 L_fin
L_rpoll:
  buffer_load_dwordx4 v[20:23], v57, s[24:27], s91 offen sc1
  s_sub_u32 s68, s68, 1
  s_cmp_eq_u32 s68, 0
  s_cbranch_scc1 L_fin
  s_waitcnt vmcnt(0)
  v_xor_b32 v20, s40, v20
  v_xor_b32 v21, s41, v21
  v_xor_b32 v22, s42, v22
  v_xor_b32 v23, s43, v23
  v_or3_b32 v59, v20, v21, v22
  v_or_b32 v59, v59, v23
  v_cmp_ne_u32_sdwa vcc, v59, 0 src0_sel:BYTE_0 src1_sel:DWORD
  s_wqm_b64 exec, vcc
  s_cbranch_scc1 L_rpoll
  s_mov_b64 exec, -1
  v_permlane32_swap_b32 v20, v21
  v_permlane32_swap_b32 v22, v23
  v_add_f32 v20, v20, v21
  v_add_f32 v22, v22, v23
  s_nop 1
  v_permlane16_swap_b32 v20, v22
  v_add_f32 v20, v20, v22
  ds_write_b32 v55, v20 offset:8704
  ds_add_rtn_u32 v191, v60, v62 offset:1280
  ds_read_b32 v24, v60 offset:8704
  ds_read_b32 v25, v60 offset:8960
  ds_read_b32 v26, v60 offset:9216
  ds_read_b32 v27, v60 offset:9472
  s_waitcnt lgkmcnt(0)
  v_cmp_eq_u32 vcc, 3, v191
  v_add_f32 v24, v24, v25
  v_add_f32 v26, v26, v27
  v_add_f32 v24, v24, v26
  s_cbranch_vccz L_fin
  s_nop 0
  v_add_f32_dpp v24, v24, v24 row_ror:8 row_mask:0xf bank_mask:0xf
  s_mov_b32 exec_lo, 0x00ff00ff
  s_mov_b32 exec_hi, 0x00ff00ff
  v_cvt_pk_bf16_f32 v24, v24, v24
  buffer_store_short v24, v58, s[28:31], s92 offen
  s_branch L_fin
L_helper:
  s_sub_u32 s39, s3, 4
  v_lshrrev_b32 v1, 4, v0
  v_and_b32 v2, 15, v0
  v_mov_b32 v14, 0
  s_lshr_b32 s34, s32, 4
  s_and_b32 s35, s32, 15
  s_mov_b32 s22, 3670016
  s_mov_b32 s44, 0x07060500
  s_mov_b32 s45, 0x07060501
  s_mov_b32 s46, 0x07060502
  s_mov_b32 s47, 0x07060503
  s_cmp_lg_u32 s39, 0
  s_cbranch_scc1 L_h_other
  v_mov_b32 v40, 0
  v_mov_b32 v41, 0
  v_mov_b32 v42, 0
  v_mov_b32 v43, 0
  v_lshlrev_b32 v12, 4, v0
  ds_write_b128 v12, v[40:43] offset:512
  ds_write_b128 v12, v[40:43] offset:1536
  v_mul_u32_u24 v4, 229376, v1
  v_lshl_add_u32 v4, v2, 3, v4
  v_bfe_u32 v5, v0, 2, 1
  v_mul_u32_u24 v5, 896, v5
  v_mul_u32_u24 v6, 56, v1
  v_add_u32 v5, v5, v6
  s_lshl_b32 s87, s34, 3
  s_add_u32 s87, s87, s33
  s_lshl_b32 s94, s35, 13
  s_add_u32 s94, s94, 4096
  s_mov_b32 s89, 1
  s_mov_b32 s30, 1792
  s_getreg_b32 s63, hwreg(HW_REG_XCC_ID, 0, 4)
  s_waitcnt lgkmcnt(0)
  s_load_dword s86, s[18:19], 0
  s_mov_b32 s28, s4
  s_mov_b32 s29, s5
  s_mov_b32 s20, s10
  s_mov_b32 s21, s11
  s_mov_b32 s24, s18
  s_mov_b32 s25, s19
  s_barrier
L_tile:
  s_lshr_b32 s61, s87, 2
  s_and_b32 s62, s87, 3
  s_mul_i32 s37, s61, 917504
  s_lshl_b32 s38, s35, 9
  s_add_u32 s37, s37, s38
  s_lshl_b32 s38, s62, 7
  s_add_u32 s37, s37, s38
  s_mul_i32 s36, s61, 224
  buffer_load_dwordx4 v[16:19], v5, s[28:31], s36 offen offset:0
  buffer_load_dwordx4 v[20:23], v5, s[28:31], s36 offen offset:16
  buffer_load_dwordx4 v[24:27], v5, s[28:31], s36 offen offset:32
  buffer_load_dwordx2 v[28:29], v5, s[28:31], s36 offen offset:48
  buffer_load_dwordx2 v[64:65], v4, s[20:23], s37 offen nt
  s_add_u32 s37, s37, 8192
  buffer_load_dwordx2 v[66:67], v4, s[20:23], s37 offen nt
  s_add_u32 s37, s37, 8192
  buffer_load_dwordx2 v[68:69], v4, s[20:23], s37 offen nt
  s_add_u32 s37, s37, 8192
  buffer_load_dwordx2 v[70:71], v4, s[20:23], s37 offen nt
  s_add_u32 s37, s37, 8192
  buffer_load_dwordx2 v[72:73], v4, s[20:23], s37 offen nt
  s_add_u32 s37, s37, 8192
  buffer_load_dwordx2 v[74:75], v4, s[20:23], s37 offen nt
  s_add_u32 s37, s37, 8192
  buffer_load_dwordx2 v[76:77], v4, s[20:23], s37 offen nt
  s_add_u32 s37, s37, 8192
  buffer_load_dwordx2 v[78:79], v4, s[20:23], s37 offen nt
  s_add_u32 s37, s37, 8192
  buffer_load_dwordx2 v[80:81], v4, s[20:23], s37 offen nt
  s_add_u32 s37, s37, 8192
  buffer_load_dwordx2 v[82:83], v4, s[20:23], s37 offen nt
  s_add_u32 s37, s37, 8192
  buffer_load_dwordx2 v[84:85], v4, s[20:23], s37 offen nt
  s_add_u32 s37, s37, 8192
  buffer_load_dwordx2 v[86:87], v4, s[20:23], s37 offen nt
  s_add_u32 s37, s37, 8192
  buffer_load_dwordx2 v[88:89], v4, s[20:23], s37 offen nt
  s_add_u32 s37, s37, 8192
  buffer_load_dwordx2 v[90:91], v4, s[20:23], s37 offen nt
  s_add_u32 s37, s37, 8192
  buffer_load_dwordx2 v[92:93], v4, s[20:23], s37 offen nt
  s_add_u32 s37, s37, 8192
  buffer_load_dwordx2 v[94:95], v4, s[20:23], s37 offen nt
  s_add_u32 s37, s37, 8192
  buffer_load_dwordx2 v[96:97], v4, s[20:23], s37 offen nt
  s_add_u32 s37, s37, 8192
  buffer_load_dwordx2 v[98:99], v4, s[20:23], s37 offen nt
  s_add_u32 s37, s37, 8192
  buffer_load_dwordx2 v[100:101], v4, s[20:23], s37 offen nt
  s_add_u32 s37, s37, 8192
  buffer_load_dwordx2 v[102:103], v4, s[20:23], s37 offen nt
  s_add_u32 s37, s37, 8192
  buffer_load_dwordx2 v[104:105], v4, s[20:23], s37 offen nt
  s_add_u32 s37, s37, 8192
  buffer_load_dwordx2 v[106:107], v4, s[20:23], s37 offen nt
  s_add_u32 s37, s37, 8192
  buffer_load_dwordx2 v[108:109], v4, s[20:23], s37 offen nt
  s_add_u32 s37, s37, 8192
  buffer_load_dwordx2 v[110:111], v4, s[20:23], s37 offen nt
  s_add_u32 s37, s37, 8192
  buffer_load_dwordx2 v[112:113], v4, s[20:23], s37 offen nt
  s_add_u32 s37, s37, 8192
  buffer_load_dwordx2 v[114:115], v4, s[20:23], s37 offen nt
  s_add_u32 s37, s37, 8192
  buffer_load_dwordx2 v[116:117], v4, s[20:23], s37 offen nt
  s_add_u32 s37, s37, 8192
  buffer_load_dwordx2 v[118:119], v4, s[20:23], s37 offen nt
  s_cmp_eq_u32 s89, 0
  s_cbranch_scc1 L_tile_go
  v_and_b32 v6, 1, v0
  v_lshlrev_b32 v6, 4, v6
  v_and_b32 v7, 10, v0
  v_mov_b32 v10, 0x0c0c0c0c
  v_mov_b32 v8, 0xd0c
  v_lshlrev_b32 v8, v6, v8
  v_xor_b32 v8, v10, v8
  v_cmp_eq_u32 vcc, 0, v7
  s_nop 1
  v_cndmask_b32 v32, v10, v8, vcc
  v_cmp_eq_u32 vcc, 2, v7
  s_nop 1
  v_cndmask_b32 v33, v10, v8, vcc
  v_mov_b32 v8, 0xf0e
  v_lshlrev_b32 v8, v6, v8
  v_xor_b32 v8, v10, v8
  v_cmp_eq_u32 vcc, 0, v7
  s_nop 1
  v_cndmask_b32 v34, v10, v8, vcc
  v_cmp_eq_u32 vcc, 2, v7
  s_nop 1
  v_cndmask_b32 v35, v10, v8, vcc
  v_mov_b32 v8, 0x88ff
  v_and_b32 v6, 12, v0
  ds_write_b32 v6, v8 offset:528
  s_waitcnt lgkmcnt(0)
  s_add_u32 s86, s86, 0x01011001
  v_mov_b32 v13, s86
  ds_write_b32 v14, v13 offset:512
  s_bfe_u32 s40, s86, 0x80000
  s_bfe_u32 s41, s86, 0x80008
  s_bfe_u32 s42, s86, 0x80010
  s_bfe_u32 s43, s86, 0x80018
  s_lshl_b32 s38, s63, 8
  s_xor_b32 s38, s38, s86
  v_mov_b32 v10, s38
  s_bfe_u32 s52, s38, 0x80000
  s_bfe_u32 s53, s38, 0x80008
  s_bfe_u32 s54, s38, 0x80010
  s_bfe_u32 s55, s38, 0x80018
L_tile_go:
  v_mov_b32 v40, 0
  v_mov_b32 v41, 0
  v_mov_b32 v42, 0
  v_mov_b32 v43, 0
  s_lshl_b32 s37, s87, 8
  s_add_u32 s37, s37, s94
  v_lshlrev_b32 v11, 12, v1
  v_lshl_add_u32 v11, v2, 4, v11
  s_lshl_b32 s95, s34, 12
  s_add_u32 s95, s95, s94
  s_waitcnt vmcnt(28)
  v_perm_b32 v44, v16, v16, v32
  v_perm_b32 v45, v16, v16, v33
  v_perm_b32 v46, v16, v16, v34
  v_perm_b32 v47, v16, v16, v35
  s_waitcnt vmcnt(26)
  s_nop 0
  v_mfma_f32_16x16x32_bf16 v[40:43], v[44:47], v[64:67], v[40:43]
  v_perm_b32 v36, v17, v17, v32
  v_perm_b32 v37, v17, v17, v33
  v_perm_b32 v38, v17, v17, v34
  v_perm_b32 v39, v17, v17, v35
  s_waitcnt vmcnt(24)
  s_nop 0
  v_mfma_f32_16x16x32_bf16 v[40:43], v[36:39], v[68:71], v[40:43]
  v_perm_b32 v44, v18, v18, v32
  v_perm_b32 v45, v18, v18, v33
  v_perm_b32 v46, v18, v18, v34
  v_perm_b32 v47, v18, v18, v35
  s_waitcnt vmcnt(22)
  s_nop 0
  v_mfma_f32_16x16x32_bf16 v[40:43], v[44:47], v[72:75], v[40:43]
  v_perm_b32 v36, v19, v19, v32
  v_perm_b32 v37, v19, v19, v33
  v_perm_b32 v38, v19, v19, v34
  v_perm_b32 v39, v19, v19, v35
  s_waitcnt vmcnt(20)
  s_nop 0
  v_mfma_f32_16x16x32_bf16 v[40:43], v[36:39], v[76:79], v[40:43]
  v_perm_b32 v44, v20, v20, v32
  v_perm_b32 v45, v20, v20, v33
  v_perm_b32 v46, v20, v20, v34
  v_perm_b32 v47, v20, v20, v35
  s_waitcnt vmcnt(18)
  s_nop 0
  v_mfma_f32_16x16x32_bf16 v[40:43], v[44:47], v[80:83], v[40:43]
  v_perm_b32 v36, v21, v21, v32
  v_perm_b32 v37, v21, v21, v33
  v_perm_b32 v38, v21, v21, v34
  v_perm_b32 v39, v21, v21, v35
  s_waitcnt vmcnt(16)
  s_nop 0
  v_mfma_f32_16x16x32_bf16 v[40:43], v[36:39], v[84:87], v[40:43]
  v_perm_b32 v44, v22, v22, v32
  v_perm_b32 v45, v22, v22, v33
  v_perm_b32 v46, v22, v22, v34
  v_perm_b32 v47, v22, v22, v35
  s_waitcnt vmcnt(14)
  s_nop 0
  v_mfma_f32_16x16x32_bf16 v[40:43], v[44:47], v[88:91], v[40:43]
  v_perm_b32 v36, v23, v23, v32
  v_perm_b32 v37, v23, v23, v33
  v_perm_b32 v38, v23, v23, v34
  v_perm_b32 v39, v23, v23, v35
  s_waitcnt vmcnt(12)
  s_nop 0
  v_mfma_f32_16x16x32_bf16 v[40:43], v[36:39], v[92:95], v[40:43]
  v_perm_b32 v44, v24, v24, v32
  v_perm_b32 v45, v24, v24, v33
  v_perm_b32 v46, v24, v24, v34
  v_perm_b32 v47, v24, v24, v35
  s_waitcnt vmcnt(10)
  s_nop 0
  v_mfma_f32_16x16x32_bf16 v[40:43], v[44:47], v[96:99], v[40:43]
  v_perm_b32 v36, v25, v25, v32
  v_perm_b32 v37, v25, v25, v33
  v_perm_b32 v38, v25, v25, v34
  v_perm_b32 v39, v25, v25, v35
  s_waitcnt vmcnt(8)
  s_nop 0
  v_mfma_f32_16x16x32_bf16 v[40:43], v[36:39], v[100:103], v[40:43]
  v_perm_b32 v44, v26, v26, v32
  v_perm_b32 v45, v26, v26, v33
  v_perm_b32 v46, v26, v26, v34
  v_perm_b32 v47, v26, v26, v35
  s_waitcnt vmcnt(6)
  s_nop 0
  v_mfma_f32_16x16x32_bf16 v[40:43], v[44:47], v[104:107], v[40:43]
  v_perm_b32 v36, v27, v27, v32
  v_perm_b32 v37, v27, v27, v33
  v_perm_b32 v38, v27, v27, v34
  v_perm_b32 v39, v27, v27, v35
  s_waitcnt vmcnt(4)
  s_nop 0
  v_mfma_f32_16x16x32_bf16 v[40:43], v[36:39], v[108:111], v[40:43]
  v_perm_b32 v44, v28, v28, v32
  v_perm_b32 v45, v28, v28, v33
  v_perm_b32 v46, v28, v28, v34
  v_perm_b32 v47, v28, v28, v35
  s_waitcnt vmcnt(2)
  s_nop 0
  v_mfma_f32_16x16x32_bf16 v[40:43], v[44:47], v[112:115], v[40:43]
  v_perm_b32 v36, v29, v29, v32
  v_perm_b32 v37, v29, v29, v33
  v_perm_b32 v38, v29, v29, v34
  v_perm_b32 v39, v29, v29, v35
  s_waitcnt vmcnt(0)
  s_nop 0
  v_mfma_f32_16x16x32_bf16 v[40:43], v[36:39], v[116:119], v[40:43]
  s_nop 7
  v_perm_b32 v44, v40, v10, s44
  v_perm_b32 v45, v41, v10, s45
  v_perm_b32 v46, v42, v10, s46
  v_perm_b32 v47, v43, v10, s47
  s_mov_b32 exec_hi, 0
  buffer_store_dwordx4 v[44:47], v11, s[24:27], s37 offen
  s_mov_b32 exec_hi, -1
  s_mov_b32 s68, 48
  s_cmp_lg_u32 s89, 0
  s_cbranch_scc1 L_qpoll
  s_waitcnt vmcnt(0)
  s_add_u32 s87, s87, 1
  s_cmp_lt_u32 s87, 16
  s_cbranch_scc1 L_tile
  s_mov_b32 s68, 1048576
L_qpoll:
  buffer_load_dwordx4 v[48:51], v12, s[24:27], s95 offen offset:0 sc1
  buffer_load_dwordx4 v[52:55], v12, s[24:27], s95 offen offset:1024 sc1
  buffer_load_dwordx4 v[56:59], v12, s[24:27], s95 offen offset:2048 sc1
  buffer_load_dwordx4 v[60:63], v12, s[24:27], s95 offen offset:3072 sc1
  s_waitcnt vmcnt(0)
  v_xor_b32 v48, s52, v48
  v_xor_b32 v49, s53, v49
  v_xor_b32 v50, s54, v50
  v_xor_b32 v51, s55, v51
  v_xor_b32 v52, s52, v52
  v_xor_b32 v53, s53, v53
  v_xor_b32 v54, s54, v54
  v_xor_b32 v55, s55, v55
  v_xor_b32 v56, s52, v56
  v_xor_b32 v57, s53, v57
  v_xor_b32 v58, s54, v58
  v_xor_b32 v59, s55, v59
  v_xor_b32 v60, s52, v60
  v_xor_b32 v61, s53, v61
  v_xor_b32 v62, s54, v62
  v_xor_b32 v63, s55, v63
  v_or3_b32 v15, v48, v49, v50
  v_or3_b32 v15, v15, v51, v52
  v_or3_b32 v15, v15, v53, v54
  v_or3_b32 v15, v15, v55, v56
  v_or3_b32 v15, v15, v57, v58
  v_or3_b32 v15, v15, v59, v60
  v_or3_b32 v15, v15, v61, v62
  v_or_b32 v15, v15, v63
  v_cmp_ne_u32_sdwa vcc, v15, 0 src0_sel:BYTE_0 src1_sel:DWORD
  s_cbranch_vccz L_qgo
  s_sub_u32 s68, s68, 1
  s_cmp_eq_u32 s68, 0
  s_cbranch_scc0 L_qpoll
  s_cmp_eq_u32 s89, 0
  s_cbranch_scc1 L_qgo
L_qfail:
  s_waitcnt vmcnt(0)
  s_mov_b32 s89, 0
  s_mov_b32 s87, 0
  s_lshl_b32 s94, s2, 13
  s_add_u32 s94, s94, 2097152
  s_branch L_tile
L_qgo:
  v_add_f32 v48, v48, v52
  v_add_f32 v56, v56, v60
  v_add_f32 v49, v49, v53
  v_add_f32 v57, v57, v61
  v_add_f32 v50, v50, v54
  v_add_f32 v58, v58, v62
  v_add_f32 v51, v51, v55
  v_add_f32 v59, v59, v63
  v_add_f32 v48, v48, v56
  v_add_f32 v49, v49, v57
  v_add_f32 v50, v50, v58
  v_add_f32 v51, v51, v59
  v_cvt_pk_bf16_f32 v48, v48, v49
  v_cvt_pk_bf16_f32 v49, v50, v51
  v_lshlrev_b32 v15, 3, v0
  v_mov_b32 v50, 1
  ds_write_b64 v15, v[48:49] offset:0
  s_waitcnt lgkmcnt(0)
  ds_write_b32 v14, v50 offset:516
  v_and_b32 v7, 3, v0
  v_lshlrev_b32 v7, 4, v7
  s_lshl_b32 s60, s32, 10
  s_add_u32 s60, s60, 262144
  s_lshl_b32 s61, s33, 7
  s_add_u32 s61, s61, s60
  s_mov_b32 s68, 4194304
L_lpoll:
  s_sleep 4
  ds_read_b128 v[48:51], v7 offset:576
  s_sub_u32 s68, s68, 1
  s_cmp_eq_u32 s68, 0
  s_waitcnt lgkmcnt(0)
  s_cbranch_scc1 L_lgo
  v_cmp_eq_u32 vcc, 0, v51
  s_cbranch_vccnz L_lpoll
L_lgo:
  v_mov_b32 v49, v13
  v_mov_b32 v51, v13
  s_mov_b64 exec, 15
  s_cmp_eq_u32 s89, 0
  s_cbranch_scc1 L_wt34
  buffer_store_dwordx4 v[48:51], v7, s[24:27], s61 offen
  s_branch L_wd34
L_wt34:
  buffer_store_dwordx4 v[48:51], v7, s[24:27], s61 offen sc1
L_wd34:
  s_mov_b64 exec, -1
  v_bfe_u32 v8, v0, 2, 3
  v_lshl_add_u32 v8, v8, 7, v7
  s_mov_b32 s68, 1048576
L_spoll:
  s_sleep 8
  buffer_load_dwordx4 v[52:55], v8, s[24:27], s60 offen sc1
  s_sub_u32 s68, s68, 1
  s_cmp_eq_u32 s68, 0
  s_waitcnt vmcnt(0)
  s_cbranch_scc1 L_sgo
  v_xor_b32 v56, v53, v13
  v_xor_b32 v57, v55, v13
  v_or_b32 v56, v56, v57
  v_cmp_ne_u32 vcc, 0, v56
  s_cbranch_vccnz L_spoll
  s_cmp_lg_u32 s33, 0
  s_cbranch_scc1 L_sgo
  s_mov_b32 s38, 1
  s_atomic_add s38, s[16:17], 0 glc
  s_waitcnt lgkmcnt(0)
  s_cmp_lg_u32 s38, 31
  s_cbranch_scc1 L_sgo
  s_mov_b64 exec, 1
  buffer_store_dword v13, v14, s[24:27], 0 offen
  s_mov_b64 exec, -1
L_sgo:
  v_mov_b32 v56, v52
  s_nop 1
  v_max_f32_dpp v56, v56, v56 quad_perm:[1,0,3,2] row_mask:0xf bank_mask:0xf
  s_nop 1
  v_max_f32_dpp v56, v56, v56 quad_perm:[2,3,0,1] row_mask:0xf bank_mask:0xf
  s_nop 1
  v_max_f32_dpp v56, v56, v56 row_half_mirror row_mask:0xf bank_mask:0xf
  s_nop 1
  v_max_f32_dpp v56, v56, v56 row_mirror row_mask:0xf bank_mask:0xf
  v_mov_b32 v57, v56
  s_nop 1
  v_permlane16_swap_b32 v56, v57
  v_max_f32 v56, v56, v57
  v_sub_f32 v56, v52, v56
  v_exp_f32 v56, v56
  s_nop 0
  v_mul_f32 v58, v56, v54
  s_nop 1
  v_add_f32_dpp v58, v58, v58 quad_perm:[1,0,3,2] row_mask:0xf bank_mask:0xf
  s_nop 1
  v_add_f32_dpp v58, v58, v58 quad_perm:[2,3,0,1] row_mask:0xf bank_mask:0xf
  s_nop 1
  v_add_f32_dpp v58, v58, v58 row_half_mirror row_mask:0xf bank_mask:0xf
  s_nop 1
  v_add_f32_dpp v58, v58, v58 row_mirror row_mask:0xf bank_mask:0xf
  v_mov_b32 v57, v58
  s_nop 1
  v_permlane16_swap_b32 v58, v57
  v_add_f32 v58, v58, v57
  v_rcp_f32 v58, v58
  v_lshrrev_b32 v7, 2, v7
  v_mul_f32 v56, v56, v58
  s_lshl_b32 s38, s33, 2
  s_lshl_b64 exec, 15, s38
  ds_write_b32 v7, v56 offset:640
  s_mov_b64 exec, -1
  v_mov_b32 v60, v13
  v_mov_b32 v61, s89
  v_mov_b32 v62, 1
  s_load_dword s38, s[18:19], 458752
  s_mov_b32 s68, 1048576
L_ypw:
  s_waitcnt lgkmcnt(0)
  s_xor_b32 s60, s38, s86
  s_andn2_b32 s61, s60, 0x100
  s_cbranch_scc0 L_ypok
  s_sub_u32 s68, s68, 1
  s_cmp_eq_u32 s68, 0
  s_cbranch_scc1 L_ypok
  s_sleep 32
  s_mov_b32 s60, 458752
  buffer_load_dword v63, v14, s[24:27], s60 offen sc1
  s_waitcnt vmcnt(0)
  v_readfirstlane_b32 s38, v63
  s_branch L_ypw
L_ypok:
  s_and_b32 s60, s60, 0x100
  s_lshl_b32 s60, s60, 5
  v_mov_b32 v63, s60
  s_waitcnt lgkmcnt(0)
  ds_write_b128 v14, v[60:63] offset:656
  s_branch L_h_common
L_h_other:
  s_barrier
  s_waitcnt lgkmcnt(0)
  s_mov_b32 s24, s18
  s_mov_b32 s25, s19
  s_lshl_b32 s38, s2, 2
  s_add_u32 s38, s38, s39
  s_cmp_lg_u32 s38, 3
  s_cbranch_scc1 L_norace
  s_mov_b32 s60, 1277952
  s_mov_b32 s56, 0
  s_mov_b32 s38, 3
L_race:
  s_xor_b32 s61, s60, 8192
  s_load_dword s54, s[18:19], s60 glc
  s_load_dword s55, s[18:19], s61 glc
  s_waitcnt lgkmcnt(0)
  s_not_b32 s52, s54
  s_not_b32 s53, s55
  s_load_dword s52, s[18:19], s60 glc
  s_load_dword s53, s[18:19], s61 glc
  s_waitcnt lgkmcnt(1)
  s_cmp_lg_u32 s52, s54
  s_addc_u32 s56, s56, 0
  s_cmp_lg_u32 s53, s55
  s_subb_u32 s56, s56, 0
  s_waitcnt lgkmcnt(0)
  s_not_b32 s52, s54
  s_not_b32 s53, s55
  s_load_dword s53, s[18:19], s61 glc
  s_load_dword s52, s[18:19], s60 glc
  s_waitcnt lgkmcnt(1)
  s_cmp_lg_u32 s52, s54
  s_addc_u32 s56, s56, 0
  s_cmp_lg_u32 s53, s55
  s_subb_u32 s56, s56, 0
  s_waitcnt lgkmcnt(0)
  s_add_u32 s60, s60, 4352
  s_and_b32 s60, s60, 4294959103
  s_sub_u32 s38, s38, 1
  s_cmp_lg_u32 s38, 0
  s_cbranch_scc1 L_race
L_norace:
  s_mov_b32 s68, 4194304
L_hwait:
  s_sleep 8
  ds_read_b64 v[48:49], v14 offset:512
  s_sub_u32 s68, s68, 1
  s_cmp_eq_u32 s68, 0
  s_waitcnt lgkmcnt(0)
  s_cbranch_scc1 L_hok
  v_cmp_eq_u32 vcc, 0, v49
  s_cbranch_vccnz L_hwait
L_hok:
  v_readfirstlane_b32 s86, v48
  v_mov_b32 v13, v48
  s_bfe_u32 s40, s86, 0x80000
  s_bfe_u32 s41, s86, 0x80008
  s_bfe_u32 s42, s86, 0x80010
  s_bfe_u32 s43, s86, 0x80018
  s_cmp_eq_u32 s39, 1
  s_cbranch_scc1 L_ctl0
  s_cmp_eq_u32 s39, 2
  s_cbranch_scc1 L_spt2
  s_and_b32 s38, s2, 7
  s_cmp_lg_u32 s38, 0
  s_cbranch_scc1 L_h_common
  s_cmp_lg_u32 s2, 0
  s_cbranch_scc1 L_nopub
  s_cmp_gt_i32 s56, 0
  s_cselect_b32 s38, 0x100, 0
  s_xor_b32 s38, s38, s86
  v_mov_b32 v48, s38
  s_mov_b32 s38, 458752
  s_mov_b64 exec, 1
  buffer_store_dword v48, v14, s[24:27], s38 offen sc1
  s_mov_b64 exec, -1
L_nopub:
  s_lshr_b32 s38, s2, 4
  s_lshl_b32 s60, s38, 14
  s_bfe_u32 s38, s2, 0x10003
  s_lshl_b32 s38, s38, 7
  s_add_u32 s60, s60, s38
  s_add_u32 s60, s60, 1048576
  s_mov_b32 s38, 16
L_spt1:
  s_add_u32 s61, s60, 0
  s_load_dword s52, s[18:19], s61
  s_add_u32 s61, s60, 64
  s_load_dword s53, s[18:19], s61
  s_add_u32 s61, s60, 256
  s_load_dword s54, s[18:19], s61
  s_add_u32 s61, s60, 320
  s_load_dword s55, s[18:19], s61
  s_add_u32 s61, s60, 512
  s_load_dword s56, s[18:19], s61
  s_add_u32 s61, s60, 576
  s_load_dword s57, s[18:19], s61
  s_add_u32 s61, s60, 768
  s_load_dword s58, s[18:19], s61
  s_add_u32 s61, s60, 832
  s_load_dword s59, s[18:19], s61
  s_add_u32 s60, s60, 1024
  s_sub_u32 s38, s38, 1
  s_cmp_lg_u32 s38, 0
  s_waitcnt lgkmcnt(0)
  s_cbranch_scc1 L_spt1
  s_branch L_h_common
L_spt2:
  s_lshl_b32 s60, s32, 3
  s_add_u32 s60, s60, s33
  s_lshl_b32 s60, s60, 10
  s_add_u32 s60, s60, 524288
  s_mov_b32 s38, 2
L_spt3:
  s_load_dword s52, s[18:19], s60
  s_add_u32 s60, s60, 64
  s_load_dword s53, s[18:19], s60
  s_add_u32 s60, s60, 64
  s_load_dword s54, s[18:19], s60
  s_add_u32 s60, s60, 64
  s_load_dword s55, s[18:19], s60
  s_add_u32 s60, s60, 64
  s_load_dword s56, s[18:19], s60
  s_add_u32 s60, s60, 64
  s_load_dword s57, s[18:19], s60
  s_add_u32 s60, s60, 64
  s_load_dword s58, s[18:19], s60
  s_add_u32 s60, s60, 64
  s_load_dword s59, s[18:19], s60
  s_add_u32 s60, s60, 64
  s_sub_u32 s38, s38, 1
  s_cmp_lg_u32 s38, 0
  s_waitcnt lgkmcnt(0)
  s_cbranch_scc1 L_spt3
  s_cmp_lg_u32 s33, 0
  s_cbranch_scc1 L_h_common
  v_and_b32 v49, 3, v0
  v_mul_u32_u24 v49, 260, v49
  s_lshr_b32 s38, s2, 6
  s_mul_i32 s62, s38, 28
  s_add_u32 s62, s62, 48
  s_mul_i32 s63, s38, 4352
  s_add_u32 s63, s63, 1572864
  s_and_b32 s60, s2, 7
  s_lshl_b32 s60, s60, 6
  s_add_u32 s60, s60, s38
  s_lshl_b32 s60, s60, 2
  s_add_u32 s60, s60, 393344
  s_lshl_b32 s61, s86, 16
  s_mov_b32 s68, 16777216
L_rk:
  s_load_dword s64, s[18:19], s63
L_rkw:
  s_sleep 1
  ds_read_b32 v48, v49 offset:1536
  s_sub_u32 s68, s68, 1
  s_cmp_eq_u32 s68, 0
  s_waitcnt lgkmcnt(0)
  s_cbranch_scc1 L_h_common
  v_add_u32_dpp v48, v48, v48 quad_perm:[1,0,3,2] row_mask:0xf bank_mask:0xf
  s_nop 1
  v_add_u32_dpp v48, v48, v48 quad_perm:[2,3,0,1] row_mask:0xf bank_mask:0xf
  v_cmp_gt_u32 vcc, s62, v48
  s_cbranch_vccnz L_rkw
  s_mov_b32 s38, 1
  s_atomic_add s38, s[18:19], s63 glc
  s_waitcnt lgkmcnt(0)
  s_sub_u32 s38, s38, s64
  s_and_b32 s38, s38, 7
  s_lshl_b32 s38, s38, 2
  s_or_b32 s38, s38, s61
  v_mov_b32 v50, s38
  s_mov_b64 exec, 1
  buffer_store_dword v50, v14, s[24:27], s60 offen
  s_mov_b64 exec, -1
  s_add_u32 s63, s63, 17408
  s_add_u32 s62, s62, 112
  s_cmp_lt_u32 s62, 776
  s_cbranch_scc1 L_rk
  s_branch L_h_common
L_ctl0:
  s_mov_b32 s55, 0
  s_mov_b32 s58, 5504
  s_and_b32 s53, s2, 7
  s_lshl_b32 s53, s53, 8
  s_add_u32 s53, s53, 393216
  s_lshr_b32 s52, s2, 3
  s_lshl_b32 s52, s52, 2
  s_add_u32 s52, s52, s53
  s_lshl_b32 s54, s86, 16
  v_and_b32 v97, 35, v0
  v_cmp_gt_u32 vcc, 32, v0
  s_nop 1
  v_cndmask_b32 v96, v97, v0, vcc
  v_lshlrev_b32 v96, 2, v96
  v_and_b32 v103, 3, v0
  v_lshlrev_b32 v104, 2, v103
  v_mul_u32_u24 v103, 260, v103
  v_mov_b32 v98, 0
  s_mov_b32 s38, 0x80
  v_writelane_b32 v98, s38, 1
  s_mov_b32 s38, 0x88
  v_writelane_b32 v98, s38, 2
  s_mov_b32 s38, 0xa4
  v_writelane_b32 v98, s38, 3
  s_mov_b32 s38, 0xaa
  v_writelane_b32 v98, s38, 4
  s_mov_b32 s38, 0xda
  v_writelane_b32 v98, s38, 5
  s_mov_b32 s38, 0xee
  v_writelane_b32 v98, s38, 6
  s_mov_b32 s38, 0xfe
  v_writelane_b32 v98, s38, 7
  s_mov_b32 s38, 0xff
  v_writelane_b32 v98, s38, 8
  s_mov_b32 s38, 0x80ff
  v_writelane_b32 v98, s38, 9
  s_mov_b32 s38, 0x88ff
  v_writelane_b32 v98, s38, 10
  s_mov_b32 s38, 0xa4ff
  v_writelane_b32 v98, s38, 11
  s_mov_b32 s38, 0xaaff
  v_writelane_b32 v98, s38, 12
  s_mov_b32 s38, 0xdaff
  v_writelane_b32 v98, s38, 13
  s_mov_b32 s38, 0xeeff
  v_writelane_b32 v98, s38, 14
  s_mov_b32 s38, 0xfeff
  v_writelane_b32 v98, s38, 15
  s_mov_b32 s38, 0xffff
  v_writelane_b32 v98, s38, 16
  s_mov_b32 s38, 0x80ffff
  v_writelane_b32 v98, s38, 17
  s_mov_b32 s38, 0x88ffff
  v_writelane_b32 v98, s38, 18
  s_mov_b32 s38, 0xa4ffff
  v_writelane_b32 v98, s38, 19
  s_mov_b32 s38, 0xaaffff
  v_writelane_b32 v98, s38, 20
  s_mov_b32 s38, 0xdaffff
  v_writelane_b32 v98, s38, 21
  s_mov_b32 s38, 0xeeffff
  v_writelane_b32 v98, s38, 22
  s_mov_b32 s38, 0xfeffff
  v_writelane_b32 v98, s38, 23
  s_mov_b32 s38, 0xffffff
  v_writelane_b32 v98, s38, 24
  s_mov_b32 s38, 0x80ffffff
  v_writelane_b32 v98, s38, 25
  s_mov_b32 s38, 0x88ffffff
  v_writelane_b32 v98, s38, 26
  s_mov_b32 s38, 0xa4ffffff
  v_writelane_b32 v98, s38, 27
  s_mov_b32 s38, 0xaaffffff
  v_writelane_b32 v98, s38, 28
  s_mov_b32 s38, 0xdaffffff
  v_writelane_b32 v98, s38, 29
  s_mov_b32 s38, 0xeeffffff
  v_writelane_b32 v98, s38, 30
  s_mov_b32 s38, 0xfeffffff
  v_writelane_b32 v98, s38, 31
  s_mov_b32 s38, 0xffffffff
  v_writelane_b32 v98, s38, 32
  s_mov_b32 s68, 1048576
L_ctl:
  ds_read_b32 v105, v103 offset:1536
  s_sub_u32 s68, s68, 1
  s_cmp_eq_u32 s68, 0
  s_waitcnt lgkmcnt(0)
  s_cbranch_scc1 L_h_common
  v_add_u32_dpp v100, v105, v105 quad_perm:[1,0,3,2] row_mask:0xf bank_mask:0xf
  s_nop 1
  v_add_u32_dpp v100, v100, v100 quad_perm:[2,3,0,1] row_mask:0xf bank_mask:0xf
  s_nop 0
  v_readfirstlane_b32 s38, v100
  v_or_b32 v100, s54, v100
  s_add_u32 s56, s38, s55
  s_mov_b32 s55, s38
  s_mov_b64 exec, 1
  buffer_store_dword v100, v14, s[24:27], s52 offen
  s_mov_b64 exec, -1
  s_cmp_ge_u32 s38, 824
  s_cbranch_scc1 L_h_common
  buffer_load_dword v101, v96, s[24:27], s53 offen sc1
  s_waitcnt vmcnt(0)
  ds_read_b32 v105, v103 offset:1536
  v_xor_b32 v101, s54, v101
  v_cmp_le_u32 vcc, 0x10000, v101
  s_cmp_lg_u32 vcc_lo, 0
  s_cbranch_scc1 L_ctl
  s_mov_b32 s59, vcc_hi
  s_nop 1
  v_add_u32_dpp v101, v101, v101 quad_perm:[1,0,3,2] row_mask:0xf bank_mask:0xf
  s_nop 1
  v_add_u32_dpp v101, v101, v101 quad_perm:[2,3,0,1] row_mask:0xf bank_mask:0xf
  s_nop 1
  v_add_u32_dpp v101, v101, v101 row_half_mirror row_mask:0xf bank_mask:0xf
  s_nop 1
  v_add_u32_dpp v101, v101, v101 row_mirror row_mask:0xf bank_mask:0xf
  s_lshl_b32 s56, s56, 4
  v_readlane_b32 s57, v101, 0
  v_readlane_b32 s38, v101, 16
  s_add_u32 s57, s57, s38
  s_sub_u32 s57, s57, s56
  s_mul_i32 s57, s57, 5
  s_add_i32 s57, s57, s58
  v_readlane_b32 s38, v101, 32
  s_sub_u32 s38, s38, 224
  s_mul_i32 s38, s38, 6
  s_cmp_eq_u32 s59, 0
  s_cselect_b32 s38, s38, 0
  s_add_i32 s57, s57, s38
  s_waitcnt lgkmcnt(0)
  v_add_u32_dpp v100, v105, v105 quad_perm:[1,0,3,2] row_mask:0xf bank_mask:0xf
  v_lshlrev_b32 v105, 2, v105
  s_nop 0
  v_add_u32_dpp v100, v100, v100 quad_perm:[2,3,0,1] row_mask:0xf bank_mask:0xf
  v_sub_u32 v100, v100, v105
  v_mul_i32_i24 v100, 96, v100
  v_add_u32 v100, s57, v100
  v_ashrrev_i32 v100, 9, v100
  v_max_i32 v100, 0, v100
  v_min_i32 v100, 32, v100
  v_lshlrev_b32 v100, 2, v100
  ds_bpermute_b32 v101, v100, v98
  s_waitcnt lgkmcnt(0)
  ds_write_b32 v104, v101 offset:528
  s_branch L_ctl
L_h_common:
  s_lshl_b32 s62, s34, 3
  s_add_u32 s62, s62, s33
  s_cmp_ge_u32 s62, 14
  s_cbranch_scc1 L_fin
  s_mov_b32 s20, s12
  s_mov_b32 s21, s13
  v_lshrrev_b32 v5, 1, v1
  v_and_b32 v6, 1, v1
  v_lshl_add_u32 v5, v6, 1, v5
  v_mul_u32_u24 v5, 896, v5
  v_lshl_add_u32 v4, v2, 3, v5
  s_cmp_ge_u32 s62, 7
  s_cselect_b32 s60, 1, 0
  s_mul_i32 s61, s60, 7
  s_sub_u32 s61, s62, s61
  s_lshl_b32 s37, s35, 1
  s_add_u32 s37, s37, s60
  s_lshl_b32 s66, s37, 8
  s_lshl_b32 s38, s61, 14
  s_add_u32 s66, s66, s38
  s_add_u32 s66, s66, 1048576
  s_lshl_b32 s37, s37, 7
  s_and_b32 s38, s39, 1
  s_lshl_b32 s38, s38, 6
  s_add_u32 s37, s37, s38
  s_lshr_b32 s38, s39, 1
  s_lshl_b32 s38, s38, 2
  s_add_u32 s37, s37, s38
  s_mul_i32 s37, s37, 896
  s_lshl_b32 s38, s61, 7
  s_add_u32 s37, s37, s38
  s_add_u32 s52, s37, 0
  s_add_u32 s53, s37, 7168
  s_add_u32 s54, s37, 14336
  s_add_u32 s55, s37, 21504
  s_add_u32 s56, s37, 28672
  s_add_u32 s57, s37, 35840
  s_add_u32 s58, s37, 43008
  s_add_u32 s59, s37, 50176
  v_bfe_u32 v5, v0, 2, 1
  v_mul_u32_u24 v5, 0x0202, v5
  v_add_u32 v5, 0x0100, v5
  v_xor_b32 v5, 0x0c0c, v5
  v_and_b32 v6, 1, v0
  v_lshlrev_b32 v6, 4, v6
  v_lshlrev_b32 v5, v6, v5
  v_mov_b32 v7, 0x0c0c0c0c
  v_xor_b32 v5, v7, v5
  v_and_b32 v6, 10, v0
  v_cmp_eq_u32 vcc, 0, v6
  s_nop 1
  v_cndmask_b32 v44, v7, v5, vcc
  v_cmp_eq_u32 vcc, 2, v6
  s_nop 1
  v_cndmask_b32 v45, v7, v5, vcc
  v_lshrrev_b32 v5, 3, v0
  v_lshlrev_b32 v5, 10, v5
  v_and_b32 v6, 7, v0
  v_lshl_add_u32 v5, v6, 4, v5
  s_lshl_b32 s38, s60, 2
  s_add_u32 s38, s38, s39
  s_lshl_b32 s38, s38, 7
  s_lshl_b32 s64, s35, 13
  s_add_u32 s64, s64, s38
  s_add_u32 s64, s64, 524288
  s_add_u32 s65, s64, 131072
  v_mul_u32_u24 v6, 114688, v1
  v_lshl_add_u32 v6, v2, 4, v6
  s_lshl_b32 s38, s39, 9
  v_lshlrev_b32 v128, 4, v0
  v_add_u32 v129, s38, v128
  v_lshlrev_b32 v130, 2, v0
  v_mov_b32 v131, 1
  v_and_b32 v49, 3, v0
  v_mul_u32_u24 v49, 260, v49
  s_mov_b32 s68, 16777216
L_wow:
  s_sleep 1
  ds_read_b32 v48, v49 offset:1536
  s_sub_u32 s68, s68, 1
  s_cmp_eq_u32 s68, 0
  s_waitcnt lgkmcnt(0)
  s_cbranch_scc1 L_wog
  v_cmp_gt_u32 vcc, 224, v48
  s_cbranch_vccnz L_wow
L_wog:
  buffer_load_dwordx2 v[64:65], v4, s[20:23], s52 offen nt
  buffer_load_dwordx2 v[66:67], v4, s[20:23], s53 offen nt
  buffer_load_dwordx2 v[68:69], v4, s[20:23], s54 offen nt
  buffer_load_dwordx2 v[70:71], v4, s[20:23], s55 offen nt
  buffer_load_dwordx2 v[72:73], v4, s[20:23], s56 offen nt
  buffer_load_dwordx2 v[74:75], v4, s[20:23], s57 offen nt
  buffer_load_dwordx2 v[76:77], v4, s[20:23], s58 offen nt
  buffer_load_dwordx2 v[78:79], v4, s[20:23], s59 offen nt
  s_mov_b32 s68, 16777216
L_hpar:
  ds_read_b64 v[48:49], v14 offset:664
  s_sub_u32 s68, s68, 1
  s_cmp_eq_u32 s68, 0
  s_waitcnt lgkmcnt(0)
  s_cbranch_scc1 L_fin
  v_cmp_eq_u32 vcc, 0, v48
  s_cbranch_vccnz L_hpar
  v_add_u32 v6, v6, v49
  s_mov_b32 s68, 1048576
  s_waitcnt vmcnt(0)
L_opoll:
  buffer_load_dwordx4 v[48:51], v5, s[24:27], s64 offen sc1
  buffer_load_dwordx4 v[52:55], v5, s[24:27], s65 offen sc1
  s_sub_u32 s68, s68, 1
  s_cmp_eq_u32 s68, 0
  s_cbranch_scc1 L_fin
  s_waitcnt vmcnt(1)
  v_xor_b32 v48, s40, v48
  v_xor_b32 v49, s41, v49
  v_xor_b32 v50, s42, v50
  v_xor_b32 v51, s43, v51
  v_or3_b32 v56, v48, v49, v50
  s_waitcnt vmcnt(0)
  v_xor_b32 v52, s40, v52
  v_xor_b32 v53, s41, v53
  v_xor_b32 v54, s42, v54
  v_xor_b32 v55, s43, v55
  v_or3_b32 v56, v56, v51, v52
  v_or3_b32 v56, v56, v53, v54
  v_or_b32 v56, v56, v55
  v_cmp_ne_u32_sdwa vcc, v56, 0 src0_sel:BYTE_0 src1_sel:DWORD
  s_wqm_b64 exec, vcc
  s_cbranch_scc1 L_opoll
  s_mov_b64 exec, -1
  v_permlane32_swap_b32 v48, v49
  v_permlane32_swap_b32 v50, v51
  v_permlane32_swap_b32 v52, v53
  v_permlane32_swap_b32 v54, v55
  v_add_f32 v48, v48, v49
  v_add_f32 v50, v50, v51
  v_add_f32 v52, v52, v53
  v_add_f32 v54, v54, v55
  v_permlane16_swap_b32 v48, v50
  s_and_b32 s38, s2, 7
  v_permlane16_swap_b32 v52, v54
  v_add_f32 v48, v48, v50
  v_add_f32 v52, v52, v54
  s_cmp_lg_u32 s38, 0
  v_add_f32_dpp v48, v48, v48 row_ror:8 row_mask:0xf bank_mask:0xf
  v_add_f32_dpp v52, v52, v52 row_ror:8 row_mask:0xf bank_mask:0xf
  v_cvt_pk_bf16_f32 v48, v48, v52
  s_nop 1
  v_mov_b32_dpp v56, v48 row_newbcast:0 row_mask:0xf bank_mask:0xf
  v_mov_b32_dpp v57, v48 row_newbcast:1 row_mask:0xf bank_mask:0xf
  v_mov_b32_dpp v58, v48 row_newbcast:2 row_mask:0xf bank_mask:0xf
  v_mov_b32_dpp v59, v48 row_newbcast:3 row_mask:0xf bank_mask:0xf
  v_mov_b32_dpp v60, v48 row_newbcast:4 row_mask:0xf bank_mask:0xf
  v_mov_b32_dpp v61, v48 row_newbcast:5 row_mask:0xf bank_mask:0xf
  v_mov_b32_dpp v62, v48 row_newbcast:6 row_mask:0xf bank_mask:0xf
  v_mov_b32_dpp v63, v48 row_newbcast:7 row_mask:0xf bank_mask:0xf
  v_perm_b32 v80, v56, v56, v44
  v_perm_b32 v81, v56, v56, v45
  v_perm_b32 v82, v57, v57, v44
  v_perm_b32 v83, v57, v57, v45
  v_perm_b32 v84, v58, v58, v44
  v_perm_b32 v85, v58, v58, v45
  v_mfma_f32_16x16x32_bf16 v[40:43], v[80:83], v[64:67], 0
  v_perm_b32 v86, v59, v59, v44
  v_perm_b32 v87, v59, v59, v45
  v_perm_b32 v88, v60, v60, v44
  v_perm_b32 v89, v60, v60, v45
  v_mfma_f32_16x16x32_bf16 v[40:43], v[84:87], v[68:71], v[40:43]
  v_perm_b32 v90, v61, v61, v44
  v_perm_b32 v91, v61, v61, v45
  v_perm_b32 v92, v62, v62, v44
  v_perm_b32 v93, v62, v62, v45
  v_mfma_f32_16x16x32_bf16 v[40:43], v[88:91], v[72:75], v[40:43]
  v_perm_b32 v94, v63, v63, v44
  v_perm_b32 v95, v63, v63, v45
  s_nop 1
  v_mfma_f32_16x16x32_bf16 v[40:43], v[92:95], v[76:79], v[40:43]
  s_mov_b32 exec_hi, 0
  s_nop 6
  ds_write_b128 v129, v[40:43] offset:6656
  ds_add_rtn_u32 v132, v130, v131 offset:1024
  ds_read_b128 v[100:103], v128 offset:6656
  ds_read_b128 v[104:107], v128 offset:7168
  ds_read_b128 v[108:111], v128 offset:7680
  ds_read_b128 v[112:115], v128 offset:8192
  s_waitcnt lgkmcnt(2)
  v_cmp_eq_u32 vcc, 3, v132
  s_cbranch_vccz L_ynot
  v_pk_add_f32 v[100:101], v[100:101], v[104:105]
  v_pk_add_f32 v[102:103], v[102:103], v[106:107]
  s_waitcnt lgkmcnt(1)
  v_pk_add_f32 v[100:101], v[100:101], v[108:109]
  v_pk_add_f32 v[102:103], v[102:103], v[110:111]
  s_waitcnt lgkmcnt(0)
  v_pk_add_f32 v[100:101], v[100:101], v[112:113]
  v_pk_add_f32 v[102:103], v[102:103], v[114:115]
  v_perm_b32 v100, v100, v13, s44
  v_perm_b32 v101, v101, v13, s45
  v_perm_b32 v102, v102, v13, s46
  v_perm_b32 v103, v103, v13, s47
  buffer_store_dwordx4 v[100:103], v6, s[24:27], s66 offen sc1
L_ynot:
  s_cbranch_scc1 L_fin
  s_barrier
L_fin:
L_end:
  s_endpgm
.section .rodata,"a"
.p2align 6
.amdhsa_kernel standalone__mha_block_cached__decode_kernel
  .amdhsa_next_free_vgpr 192
  .amdhsa_next_free_sgpr 96
  .amdhsa_accum_offset 192
  .amdhsa_group_segment_fixed_size 0
  .amdhsa_kernarg_size 64
  .amdhsa_user_sgpr_count 2
  .amdhsa_user_sgpr_kernarg_segment_ptr 1
  .amdhsa_system_sgpr_workgroup_id_x 1
  .amdhsa_float_denorm_mode_32 3
.end_amdhsa_kernel
```
